```python
import torch

def _softmax(x, axis=-1):
    return torch.softmax(x, dim=axis)
def _gelu(x):
    return torch.nn.functional.gelu(x, approximate="tanh")
def _silu(x):
    return torch.nn.functional.silu(x)
def _sigmoid(x):
    return torch.sigmoid(x)
def _layernorm(x, axis=-1, eps=1e-5):
    m = x.mean(dim=axis, keepdim=True)
    v = x.var(dim=axis, keepdim=True, unbiased=False)
    return (x - m) / torch.sqrt(v + eps)
def _scatter_add(tgt, idx, src, axis=0):
    return tgt.clone().index_add_(axis, idx, src)
def _segment_sum(src, seg, n):
    out = torch.zeros((n,) + src.shape[1:], dtype=src.dtype)
    return out.index_add_(0, seg, src)
def _pad(x, pw):
    flat = tuple(v for pair in reversed(pw) for v in pair)
    return torch.nn.functional.pad(x, flat)

kernel_name = 'gated_mix__softmax_full_mha__linear_attn_block__prompt'

def setup_inputs():

    _w = (lambda a: (lambda t: t.to(torch.bfloat16) if t.is_floating_point() else t)(torch.as_tensor(a)))
    def _A_setup():
        B, S, D = 1, 2048, 512
        return {
            "x": _w((lambda *s: torch.randn(*s, dtype=torch.bfloat16) * 0.05)(B, S, D)),
            "wqkv": _w((lambda *s: torch.randn(*s, dtype=torch.bfloat16) * 0.8)(D, 3 * D)),
            "wo": _w((lambda *s: torch.randn(*s, dtype=torch.bfloat16) * 0.05)(D, D)),
        }
    _A_in = _A_setup()

    def _B_setup():
        B, S, D = 1, 2048, 512
        return {
            "x": _w((lambda *s: torch.randn(*s, dtype=torch.bfloat16) * 0.05)(B, S, D)),
            "wqkv": _w((lambda *s: torch.randn(*s, dtype=torch.bfloat16) * 0.8)(D, 3 * D)),
            "wo": _w((lambda *s: torch.randn(*s, dtype=torch.bfloat16) * 0.2)(D, D)),
        }
    _B_in = _B_setup()

    return {
        "A_x": _A_in["x"],
        "A_wqkv": _A_in["wqkv"],
        "A_wo": _A_in["wo"],
        "B_x": _B_in["x"],
        "B_wqkv": _B_in["wqkv"],
        "B_wo": _B_in["wo"],
        "gate_w": _w((lambda *s: torch.randn(*s, dtype=torch.bfloat16) * 0.05)(512) * 16.0),
    }

def reference(A_x, A_wqkv, A_wo, B_x, B_wqkv, B_wo, gate_w):
    def _A_ref(x, wqkv, wo):
        B, S, D = x.shape
        H = 32; Dh = D // H
        qkv = (lambda x, *d: x.permute(*d))((x @ wqkv).reshape(B, S, 3, H, Dh), 2, 0, 3, 1, 4)
        q, k, v = qkv[0], qkv[1], qkv[2]
        scale = Dh ** -0.5
        scores = torch.einsum("bhqd,bhkd->bhqk", q, k) * scale
        p = _softmax(scores, axis=-1)
        o = torch.einsum("bhqk,bhkd->bhqd", p, v)
        return (lambda x, *d: x.permute(*d))(o, 0, 2, 1, 3).reshape(B, S, D) @ wo

    def _B_ref(x, wqkv, wo):
        B, S, D = x.shape
        H = 32; Dh = D // H
        qkv = (lambda x, *d: x.permute(*d))((x @ wqkv).reshape(B, S, 3, H, Dh), 2, 0, 3, 1, 4)
        q, k, v = qkv[0], qkv[1], qkv[2]
        phi = lambda t: torch.where(t > 0, t + 1, torch.exp(t)) + 1e-6
        pq, pk = phi(q), phi(k)
        kv = torch.einsum("bhsd,bhse->bhde", pk, v)
        z = torch.einsum("bhsd->bhd", pk)
        num = torch.einsum("bhqd,bhde->bhqe", pq, kv)
        den = torch.einsum("bhqd,bhd->bhq", pq, z)[..., None] + 1e-6
        o = num / den
        return (lambda x, *d: x.permute(*d))(o, 0, 2, 1, 3).reshape(B, S, D) @ wo

    x = A_x
    g = _sigmoid((x * gate_w).sum(-1, keepdims=True))
    a = _A_ref(x, A_wqkv, A_wo)
    b = _B_ref(x, B_wqkv, B_wo)
    return g * a + (1 - g) * b
```

```asm
; @launch grid=(256,1,1) block=(512,1,1) lds=163840
.amdgcn_target "amdgcn-amd-amdhsa--gfx950"
.text
.globl gated_mix__softmax_full_mha__linear_attn_block__prompt_kernel
.p2align 8
.type gated_mix__softmax_full_mha__linear_attn_block__prompt_kernel,@function
gated_mix__softmax_full_mha__linear_attn_block__prompt_kernel:
    s_load_dwordx2 s[4:5], s[0:1], 0
    s_load_dwordx2 s[8:9], s[0:1], 8
    s_load_dwordx2 s[40:41], s[0:1], 48
    s_load_dwordx2 s[12:13], s[0:1], 32
    s_load_dwordx2 s[24:25], s[0:1], 16
    s_load_dwordx2 s[28:29], s[0:1], 40
    s_load_dwordx2 s[32:33], s[0:1], 56
    s_load_dwordx2 s[36:37], s[0:1], 64
    s_load_dwordx2 s[16:17], s[0:1], 72
    s_cmp_ge_u32 s2, 256
    s_cbranch_scc1 L_end
    v_lshrrev_b32 v1, 6, v0
    v_and_b32 v255, 63, v0
    v_readfirstlane_b32 s47, v1
    s_lshr_b32 s50, s2, 3
    s_and_b32 s44, s2, 3
    s_lshl_b32 s44, s44, 1
    s_and_b32 s51, s50, 1
    s_add_u32 s44, s44, s51
    s_and_b32 s45, s2, 4
    s_lshl_b32 s45, s45, 2
    s_lshr_b32 s52, s2, 4
    s_add_u32 s45, s45, s52
    s_lshl_b32 s46, s51, 2
    s_add_u32 s46, s46, s52
    s_and_b32 s46, s46, 7
    s_and_b32 s66, s47, 3
    s_lshr_b32 s67, s47, 2
    s_cmp_ge_u32 s47, 4
    s_cbranch_scc0 L_compute
    s_mov_b32 s6, 0x200000
    s_mov_b32 s7, 0x00020000
    s_mov_b32 s10, 0x180000
    s_mov_b32 s11, 0x00020000
    v_lshrrev_b32 v1, 3, v255
    v_and_b32 v2, 7, v255
    v_lshrrev_b32 v3, 4, v255
    v_xor_b32 v3, v3, v2
    v_lshlrev_b32 v8, 10, v1
    v_lshl_add_u32 v8, v3, 4, v8
    v_xor_b32 v9, 64, v8
    v_add_u32 v9, 7168, v9
    v_bfe_u32 v3, v255, 4, 1
    v_lshlrev_b32 v3, 2, v3
    v_xor_b32 v3, v3, v2
    v_lshlrev_b32 v3, 4, v3
    v_mul_u32_u24 v4, 3072, v1
    v_add_u32 v4, v4, v3
    v_add_u32 v5, 23552, v4
    v_add_u32 v6, 47104, v4
    v_add_u32 v7, 70656, v4
    s_lshl_b32 s55, s45, 16
    s_lshl_b32 s49, s66, 14
    s_add_u32 s55, s55, s49
    s_lshr_b32 s49, s66, 1
    s_add_u32 s52, s44, s49
    s_add_u32 s52, s52, 1
    s_and_b32 s52, s52, 7
    s_lshl_b32 s52, s52, 7
    s_lshl_b32 s49, s49, 10
    s_add_u32 s56, s52, s49
    s_add_u32 s56, s56, 1024
    s_and_b32 s49, s66, 1
    s_mul_i32 s49, s49, 98304
    s_add_u32 s56, s56, s49
    s_lshl_b32 s53, s66, 11
    s_lshl_b32 s54, s66, 12
    s_waitcnt lgkmcnt(0)
    s_add_u32 s49, s46, 0
    s_and_b32 s49, s49, 7
    s_lshl_b32 s50, s49, 7
    s_add_u32 s50, s50, s55
    s_add_u32 m0, s53, 0
    s_mul_i32 s51, s49, 196608
    buffer_load_dwordx4 v8, s[4:7], s50 offen lds
    buffer_load_dwordx4 v9, s[4:7], s50 offen offset:1024 lds
    s_add_u32 m0, s54, 65536
    s_add_u32 s51, s51, s56
    buffer_load_dwordx4 v4, s[8:11], s51 offen offset:0 lds
    buffer_load_dwordx4 v5, s[8:11], s51 offen offset:1024 lds
    buffer_load_dwordx4 v6, s[8:11], s51 offen offset:2048 lds
    buffer_load_dwordx4 v7, s[8:11], s51 offen offset:3072 lds
    s_mov_b32 s42, 0x400
    s_mov_b32 s43, 0x00020000
    s_mov_b32 m0, 147456
    v_lshlrev_b32 v14, 4, v255
    buffer_load_dwordx4 v14, s[40:43], 0 offen lds
    s_add_u32 s49, s46, 1
    s_and_b32 s49, s49, 7
    s_lshl_b32 s50, s49, 7
    s_add_u32 s50, s50, s55
    s_add_u32 m0, s53, 8192
    s_mul_i32 s51, s49, 196608
    buffer_load_dwordx4 v8, s[4:7], s50 offen lds
    buffer_load_dwordx4 v9, s[4:7], s50 offen offset:1024 lds
    s_add_u32 m0, s54, 81920
    s_add_u32 s51, s51, s56
    buffer_load_dwordx4 v4, s[8:11], s51 offen offset:0 lds
    buffer_load_dwordx4 v5, s[8:11], s51 offen offset:1024 lds
    buffer_load_dwordx4 v6, s[8:11], s51 offen offset:2048 lds
    buffer_load_dwordx4 v7, s[8:11], s51 offen offset:3072 lds
    s_mov_b32 s14, 0x180000
    s_mov_b32 s15, 0x00020000
    s_mov_b32 s22, 0x180000
    s_mov_b32 s23, 0x00020000
    s_mov_b32 s26, 0x80000
    s_mov_b32 s27, 0x00020000
    s_mov_b32 s30, 0x80000
    s_mov_b32 s31, 0x00020000
    s_mov_b32 s34, 0x200000
    s_mov_b32 s35, 0x00020000
    s_mov_b32 s38, 0x100
    s_mov_b32 s39, 0x00020000
    s_mov_b32 s18, 0xd00000
    s_mov_b32 s19, 0x00020000
    s_cmp_eq_u32 s66, 2
    s_cselect_b32 s20, s8, s12
    s_cselect_b32 s21, s9, s13
    v_lshlrev_b32 v248, 4, v255
    v_lshrrev_b32 v1, 5, v255
    v_and_b32 v2, 15, v255
    v_lshlrev_b32 v1, 8, v1
    v_lshl_add_u32 v1, v2, 4, v1
    v_add_u32 v249, 1024, v1
    v_mov_b32 v250, 0xdddd
    s_mov_b32 s62, 0xffff
    s_mov_b32 s63, 0xffff
    s_mov_b32 s72, 0xffff0000
    s_mov_b32 s73, 0xffff0000
    s_mov_b32 s64, 0
    s_lshl_b32 s49, s44, 2
    s_add_u32 s49, s49, s66
    s_mul_i32 s58, s49, 131072
    s_lshl_b32 s50, s67, 16
    s_add_u32 s58, s58, s50
    s_lshl_b32 s68, s45, 1
    s_add_u32 s68, s68, s67
    s_add_u32 s98, s44, 4
    s_and_b32 s98, s98, 7
    s_and_b32 s96, s2, 7
    s_lshl_b32 s96, s96, 2
    s_lshr_b32 s49, s2, 6
    s_add_u32 s96, s96, s49
    s_lshl_b32 s96, s96, 1
    s_add_u32 s96, s96, s67
    s_bfe_u32 s97, s2, 0x30003
    s_and_b32 s61, s45, 15
    s_mul_i32 s61, s61, 4096
    v_and_b32 v1, 27, v255
    v_cmp_eq_u32 vcc, 16, v1
    v_mov_b32 v2, 0
    v_mov_b32 v3, 0x3f803f80
    v_cndmask_b32 v1, v2, v3, vcc
    v_mov_b32 v192, v1
    v_mov_b32 v193, v1
    v_mov_b64 v[194:195], v[192:193]
    v_mov_b64 v[196:197], v[192:193]
    v_mov_b64 v[198:199], v[192:193]
    v_mov_b64 v[200:201], v[192:193]
    v_mov_b64 v[202:203], v[192:193]
    v_mov_b64 v[204:205], v[192:193]
    v_mov_b64 v[206:207], v[192:193]
    v_mov_b64 v[208:209], v[192:193]
    v_mov_b64 v[210:211], v[192:193]
    v_mov_b64 v[212:213], v[192:193]
    v_mov_b64 v[214:215], v[192:193]
    v_mov_b64 v[216:217], v[192:193]
    v_mov_b64 v[218:219], v[192:193]
    v_mov_b64 v[220:221], v[192:193]
    v_mov_b64 v[222:223], v[192:193]
    v_mov_b64 v[224:225], v[192:193]
    v_mov_b64 v[226:227], v[192:193]
    v_mov_b64 v[228:229], v[192:193]
    v_mov_b64 v[230:231], v[192:193]
    v_mov_b64 v[232:233], v[192:193]
    v_mov_b64 v[234:235], v[192:193]
    v_mov_b64 v[236:237], v[192:193]
    v_mov_b64 v[238:239], v[192:193]
    v_lshrrev_b32 v1, 3, v255
    v_and_b32 v2, 7, v255
    v_bfe_u32 v3, v255, 4, 1
    v_lshlrev_b32 v3, 2, v3
    v_xor_b32 v3, v3, v2
    v_lshlrev_b32 v3, 4, v3
    v_lshl_add_u32 v240, v1, 10, v3
    s_add_u32 s49, s66, 1
    s_lshl_b32 s49, s49, 10
    s_cmp_ge_u32 s66, 2
    s_cselect_b32 s49, 0, s49
    s_cselect_b32 s52, s44, s98
    s_lshl_b32 s52, s52, 7
    s_add_u32 s57, s52, s49
    s_add_u32 s49, s44, 7
    s_and_b32 s49, s49, 7
    s_add_u32 s50, s44, 6
    s_and_b32 s50, s50, 7
    v_mov_b32 v1, s49
    v_mov_b32 v2, s50
    v_cmp_gt_u32 vcc, 32, v255
    v_and_b32 v3, 31, v255
    s_nop 0
    v_cndmask_b32 v1, v2, v1, vcc
    v_lshl_add_u32 v1, v1, 5, v3
    v_lshlrev_b32 v1, 7, v1
    v_add_u32 v254, 9437184, v1
    v_mov_b32 v13, 0
    s_waitcnt vmcnt(6)
    s_barrier
    s_add_u32 s49, s46, 2
    s_and_b32 s49, s49, 7
    s_lshl_b32 s50, s49, 7
    s_add_u32 s50, s50, s55
    s_add_u32 m0, s53, 16384
    s_mul_i32 s51, s49, 196608
    buffer_load_dwordx4 v8, s[4:7], s50 offen lds
    buffer_load_dwordx4 v9, s[4:7], s50 offen offset:1024 lds
    s_add_u32 m0, s54, 98304
    s_add_u32 s51, s51, s56
    buffer_load_dwordx4 v4, s[8:11], s51 offen offset:0 lds
    buffer_load_dwordx4 v5, s[8:11], s51 offen offset:1024 lds
    buffer_load_dwordx4 v6, s[8:11], s51 offen offset:2048 lds
    buffer_load_dwordx4 v7, s[8:11], s51 offen offset:3072 lds
    s_add_u32 s49, s46, 3
    s_and_b32 s49, s49, 7
    s_lshl_b32 s50, s49, 7
    s_add_u32 s50, s50, s55
    s_add_u32 m0, s53, 24576
    s_mul_i32 s51, s49, 196608
    buffer_load_dwordx4 v8, s[4:7], s50 offen lds
    buffer_load_dwordx4 v9, s[4:7], s50 offen offset:1024 lds
    s_add_u32 m0, s54, 114688
    s_add_u32 s51, s51, s56
    buffer_load_dwordx4 v4, s[8:11], s51 offen offset:0 lds
    buffer_load_dwordx4 v5, s[8:11], s51 offen offset:1024 lds
    buffer_load_dwordx4 v6, s[8:11], s51 offen offset:2048 lds
    buffer_load_dwordx4 v7, s[8:11], s51 offen offset:3072 lds
    s_waitcnt vmcnt(12)
    s_barrier
    s_add_u32 s49, s46, 4
    s_and_b32 s49, s49, 7
    s_lshl_b32 s50, s49, 7
    s_add_u32 s50, s50, s55
    s_add_u32 m0, s53, 32768
    s_mul_i32 s51, s49, 196608
    buffer_load_dwordx4 v8, s[4:7], s50 offen lds
    buffer_load_dwordx4 v9, s[4:7], s50 offen offset:1024 lds
    s_add_u32 m0, s54, 131072
    s_add_u32 s51, s51, s56
    buffer_load_dwordx4 v4, s[8:11], s51 offen offset:0 lds
    buffer_load_dwordx4 v5, s[8:11], s51 offen offset:1024 lds
    buffer_load_dwordx4 v6, s[8:11], s51 offen offset:2048 lds
    buffer_load_dwordx4 v7, s[8:11], s51 offen offset:3072 lds
    s_waitcnt vmcnt(12)
    s_barrier
    s_add_u32 s49, s46, 5
    s_and_b32 s49, s49, 7
    s_lshl_b32 s50, s49, 7
    s_add_u32 s50, s50, s55
    s_add_u32 m0, s53, 40960
    s_mul_i32 s51, s49, 196608
    buffer_load_dwordx4 v8, s[4:7], s50 offen lds
    buffer_load_dwordx4 v9, s[4:7], s50 offen offset:1024 lds
    s_add_u32 m0, s54, 65536
    s_add_u32 s51, s51, s56
    buffer_load_dwordx4 v4, s[8:11], s51 offen offset:0 lds
    buffer_load_dwordx4 v5, s[8:11], s51 offen offset:1024 lds
    buffer_load_dwordx4 v6, s[8:11], s51 offen offset:2048 lds
    buffer_load_dwordx4 v7, s[8:11], s51 offen offset:3072 lds
    s_waitcnt vmcnt(12)
    s_barrier
    s_add_u32 s49, s46, 6
    s_and_b32 s49, s49, 7
    s_lshl_b32 s50, s49, 7
    s_add_u32 s50, s50, s55
    s_add_u32 m0, s53, 49152
    s_mul_i32 s51, s49, 196608
    buffer_load_dwordx4 v8, s[4:7], s50 offen lds
    buffer_load_dwordx4 v9, s[4:7], s50 offen offset:1024 lds
    s_add_u32 m0, s54, 81920
    s_add_u32 s51, s51, s56
    buffer_load_dwordx4 v4, s[8:11], s51 offen offset:0 lds
    buffer_load_dwordx4 v5, s[8:11], s51 offen offset:1024 lds
    buffer_load_dwordx4 v6, s[8:11], s51 offen offset:2048 lds
    buffer_load_dwordx4 v7, s[8:11], s51 offen offset:3072 lds
    s_waitcnt vmcnt(12)
    s_barrier
    s_add_u32 s49, s46, 7
    s_and_b32 s49, s49, 7
    s_lshl_b32 s50, s49, 7
    s_add_u32 s50, s50, s55
    s_add_u32 m0, s53, 57344
    s_mul_i32 s51, s49, 196608
    buffer_load_dwordx4 v8, s[4:7], s50 offen lds
    buffer_load_dwordx4 v9, s[4:7], s50 offen offset:1024 lds
    s_add_u32 m0, s54, 98304
    s_add_u32 s51, s51, s56
    buffer_load_dwordx4 v4, s[8:11], s51 offen offset:0 lds
    buffer_load_dwordx4 v5, s[8:11], s51 offen offset:1024 lds
    buffer_load_dwordx4 v6, s[8:11], s51 offen offset:2048 lds
    buffer_load_dwordx4 v7, s[8:11], s51 offen offset:3072 lds
    s_waitcnt vmcnt(12)
    s_barrier
    s_add_u32 s49, s46, 0
    s_and_b32 s49, s49, 7
    s_mul_i32 s51, s49, 196608
    s_add_u32 m0, s54, 114688
    s_add_u32 s51, s51, s57
    buffer_load_dwordx4 v4, s[20:23], s51 offen offset:0 lds
    buffer_load_dwordx4 v5, s[20:23], s51 offen offset:1024 lds
    buffer_load_dwordx4 v6, s[20:23], s51 offen offset:2048 lds
    buffer_load_dwordx4 v7, s[20:23], s51 offen offset:3072 lds
    s_waitcnt vmcnt(10)
    s_barrier
    s_add_u32 s49, s46, 0
    s_and_b32 s49, s49, 7
    s_mul_i32 s51, s49, 196608
    s_add_u32 m0, s54, 131072
    s_add_u32 s51, s51, s57
    s_add_u32 s51, s51, 98304
    buffer_load_dwordx4 v4, s[20:23], s51 offen offset:0 lds
    buffer_load_dwordx4 v5, s[20:23], s51 offen offset:1024 lds
    buffer_load_dwordx4 v6, s[20:23], s51 offen offset:2048 lds
    buffer_load_dwordx4 v7, s[20:23], s51 offen offset:3072 lds
    s_waitcnt vmcnt(8)
    s_barrier
    s_add_u32 s49, s46, 1
    s_and_b32 s49, s49, 7
    s_mul_i32 s51, s49, 196608
    s_add_u32 m0, s54, 65536
    s_add_u32 s51, s51, s57
    buffer_load_dwordx4 v4, s[20:23], s51 offen offset:0 lds
    buffer_load_dwordx4 v5, s[20:23], s51 offen offset:1024 lds
    buffer_load_dwordx4 v6, s[20:23], s51 offen offset:2048 lds
    buffer_load_dwordx4 v7, s[20:23], s51 offen offset:3072 lds
    s_waitcnt vmcnt(8)
    s_barrier
    s_add_u32 s49, s46, 1
    s_and_b32 s49, s49, 7
    s_mul_i32 s51, s49, 196608
    s_add_u32 m0, s54, 81920
    s_add_u32 s51, s51, s57
    s_add_u32 s51, s51, 98304
    buffer_load_dwordx4 v4, s[20:23], s51 offen offset:0 lds
    buffer_load_dwordx4 v5, s[20:23], s51 offen offset:1024 lds
    buffer_load_dwordx4 v6, s[20:23], s51 offen offset:2048 lds
    buffer_load_dwordx4 v7, s[20:23], s51 offen offset:3072 lds
    s_waitcnt vmcnt(8)
    s_barrier
    s_add_u32 s49, s46, 2
    s_and_b32 s49, s49, 7
    s_mul_i32 s51, s49, 196608
    s_add_u32 m0, s54, 98304
    s_add_u32 s51, s51, s57
    buffer_load_dwordx4 v4, s[20:23], s51 offen offset:0 lds
    buffer_load_dwordx4 v5, s[20:23], s51 offen offset:1024 lds
    buffer_load_dwordx4 v6, s[20:23], s51 offen offset:2048 lds
    buffer_load_dwordx4 v7, s[20:23], s51 offen offset:3072 lds
    s_waitcnt vmcnt(8)
    s_barrier
    s_add_u32 s49, s46, 2
    s_and_b32 s49, s49, 7
    s_mul_i32 s51, s49, 196608
    s_add_u32 m0, s54, 114688
    s_add_u32 s51, s51, s57
    s_add_u32 s51, s51, 98304
    buffer_load_dwordx4 v4, s[20:23], s51 offen offset:0 lds
    buffer_load_dwordx4 v5, s[20:23], s51 offen offset:1024 lds
    buffer_load_dwordx4 v6, s[20:23], s51 offen offset:2048 lds
    buffer_load_dwordx4 v7, s[20:23], s51 offen offset:3072 lds
    s_waitcnt vmcnt(8)
    s_barrier
    s_add_u32 s49, s46, 3
    s_and_b32 s49, s49, 7
    s_mul_i32 s51, s49, 196608
    s_add_u32 m0, s54, 131072
    s_add_u32 s51, s51, s57
    buffer_load_dwordx4 v4, s[20:23], s51 offen offset:0 lds
    buffer_load_dwordx4 v5, s[20:23], s51 offen offset:1024 lds
    buffer_load_dwordx4 v6, s[20:23], s51 offen offset:2048 lds
    buffer_load_dwordx4 v7, s[20:23], s51 offen offset:3072 lds
    s_waitcnt vmcnt(8)
    s_barrier
    s_add_u32 s49, s46, 3
    s_and_b32 s49, s49, 7
    s_mul_i32 s51, s49, 196608
    s_add_u32 m0, s54, 65536
    s_add_u32 s51, s51, s57
    s_add_u32 s51, s51, 98304
    buffer_load_dwordx4 v4, s[20:23], s51 offen offset:0 lds
    buffer_load_dwordx4 v5, s[20:23], s51 offen offset:1024 lds
    buffer_load_dwordx4 v6, s[20:23], s51 offen offset:2048 lds
    buffer_load_dwordx4 v7, s[20:23], s51 offen offset:3072 lds
    s_waitcnt vmcnt(8)
    s_barrier
    s_add_u32 s49, s46, 4
    s_and_b32 s49, s49, 7
    s_mul_i32 s51, s49, 196608
    s_add_u32 m0, s54, 81920
    s_add_u32 s51, s51, s57
    buffer_load_dwordx4 v4, s[20:23], s51 offen offset:0 lds
    buffer_load_dwordx4 v5, s[20:23], s51 offen offset:1024 lds
    buffer_load_dwordx4 v6, s[20:23], s51 offen offset:2048 lds
    buffer_load_dwordx4 v7, s[20:23], s51 offen offset:3072 lds
    s_waitcnt vmcnt(8)
    s_barrier
    s_add_u32 s49, s46, 4
    s_and_b32 s49, s49, 7
    s_mul_i32 s51, s49, 196608
    s_add_u32 m0, s54, 98304
    s_add_u32 s51, s51, s57
    s_add_u32 s51, s51, 98304
    buffer_load_dwordx4 v4, s[20:23], s51 offen offset:0 lds
    buffer_load_dwordx4 v5, s[20:23], s51 offen offset:1024 lds
    buffer_load_dwordx4 v6, s[20:23], s51 offen offset:2048 lds
    buffer_load_dwordx4 v7, s[20:23], s51 offen offset:3072 lds
    s_waitcnt vmcnt(8)
    s_barrier
    s_add_u32 s49, s46, 5
    s_and_b32 s49, s49, 7
    s_mul_i32 s51, s49, 196608
    s_add_u32 m0, s54, 114688
    s_add_u32 s51, s51, s57
    buffer_load_dwordx4 v4, s[20:23], s51 offen offset:0 lds
    buffer_load_dwordx4 v5, s[20:23], s51 offen offset:1024 lds
    buffer_load_dwordx4 v6, s[20:23], s51 offen offset:2048 lds
    buffer_load_dwordx4 v7, s[20:23], s51 offen offset:3072 lds
    s_waitcnt vmcnt(8)
    s_barrier
    s_add_u32 s49, s46, 5
    s_and_b32 s49, s49, 7
    s_mul_i32 s51, s49, 196608
    s_add_u32 m0, s54, 131072
    s_add_u32 s51, s51, s57
    s_add_u32 s51, s51, 98304
    buffer_load_dwordx4 v4, s[20:23], s51 offen offset:0 lds
    buffer_load_dwordx4 v5, s[20:23], s51 offen offset:1024 lds
    buffer_load_dwordx4 v6, s[20:23], s51 offen offset:2048 lds
    buffer_load_dwordx4 v7, s[20:23], s51 offen offset:3072 lds
    s_waitcnt vmcnt(8)
    s_barrier
    s_add_u32 s49, s46, 6
    s_and_b32 s49, s49, 7
    s_mul_i32 s51, s49, 196608
    s_add_u32 m0, s54, 65536
    s_add_u32 s51, s51, s57
    buffer_load_dwordx4 v4, s[20:23], s51 offen offset:0 lds
    buffer_load_dwordx4 v5, s[20:23], s51 offen offset:1024 lds
    buffer_load_dwordx4 v6, s[20:23], s51 offen offset:2048 lds
    buffer_load_dwordx4 v7, s[20:23], s51 offen offset:3072 lds
    s_waitcnt vmcnt(8)
    s_barrier
    s_add_u32 s49, s46, 6
    s_and_b32 s49, s49, 7
    s_mul_i32 s51, s49, 196608
    s_add_u32 m0, s54, 81920
    s_add_u32 s51, s51, s57
    s_add_u32 s51, s51, 98304
    buffer_load_dwordx4 v4, s[20:23], s51 offen offset:0 lds
    buffer_load_dwordx4 v5, s[20:23], s51 offen offset:1024 lds
    buffer_load_dwordx4 v6, s[20:23], s51 offen offset:2048 lds
    buffer_load_dwordx4 v7, s[20:23], s51 offen offset:3072 lds
    s_waitcnt vmcnt(8)
    s_barrier
    s_add_u32 s49, s46, 7
    s_and_b32 s49, s49, 7
    s_mul_i32 s51, s49, 196608
    s_add_u32 m0, s54, 98304
    s_add_u32 s51, s51, s57
    buffer_load_dwordx4 v4, s[20:23], s51 offen offset:0 lds
    buffer_load_dwordx4 v5, s[20:23], s51 offen offset:1024 lds
    buffer_load_dwordx4 v6, s[20:23], s51 offen offset:2048 lds
    buffer_load_dwordx4 v7, s[20:23], s51 offen offset:3072 lds
    s_waitcnt vmcnt(8)
    s_barrier
    s_add_u32 s49, s46, 7
    s_and_b32 s49, s49, 7
    s_mul_i32 s51, s49, 196608
    s_add_u32 m0, s54, 114688
    s_add_u32 s51, s51, s57
    s_add_u32 s51, s51, 98304
    buffer_load_dwordx4 v4, s[20:23], s51 offen offset:0 lds
    buffer_load_dwordx4 v5, s[20:23], s51 offen offset:1024 lds
    buffer_load_dwordx4 v6, s[20:23], s51 offen offset:2048 lds
    buffer_load_dwordx4 v7, s[20:23], s51 offen offset:3072 lds
    s_waitcnt vmcnt(8)
    s_barrier
    s_waitcnt vmcnt(4)
    s_barrier
    buffer_load_dword v12, v13, s[36:39], 0 offen sc1
    buffer_load_dword v253, v254, s[16:19], 0 offen sc1
    s_waitcnt vmcnt(2)
    s_barrier
    s_waitcnt vmcnt(0)
    s_mov_b32 s65, 100000
L_np_3:
    v_readfirstlane_b32 s48, v12
    s_sub_u32 s65, s65, 1
    s_cbranch_scc1 L_nn_2
    s_cmp_lg_u32 s48, 0
    s_cbranch_scc1 L_nn_2
    buffer_load_dword v12, v13, s[36:39], 0 offen sc1
    s_waitcnt vmcnt(0)
    s_branch L_np_3
L_nn_2:
    s_nop 0
    s_mov_b32 s65, 100000
L_fkv_4:
    v_cmp_ne_u32 vcc, s48, v253
    s_sub_u32 s65, s65, 1
    s_cbranch_vccz L_fkvok_5
    s_cbranch_scc1 L_fkvok_5
    buffer_load_dword v253, v254, s[16:19], 0 offen sc1
    s_waitcnt vmcnt(0)
    s_branch L_fkv_4
L_fkvok_5:
    s_mov_b32 s59, s61
    s_add_u32 s60, s59, s58
    s_mov_b64 exec, s[62:63]
    buffer_load_dwordx4 v[192:195], v249, s[16:19], s60 offen sc1
    s_mov_b64 exec, -1
    buffer_load_dwordx4 v[112:115], v248, s[16:19], s60 offen sc1
    s_mov_b64 exec, s[62:63]
    buffer_load_dwordx4 v[216:219], v249, s[16:19], s60 offen offset:512 sc1
    s_add_u32 s59, s59, 2048
    s_and_b32 s59, s59, 0xffff
    s_add_u32 s60, s59, s58
    buffer_load_dwordx4 v[196:199], v249, s[16:19], s60 offen sc1
    s_mov_b64 exec, -1
    buffer_load_dwordx4 v[116:119], v248, s[16:19], s60 offen sc1
L_have_1:
    v_mov_b64 v[48:49], 0
    v_mov_b64 v[50:51], 0
    v_mov_b64 v[52:53], 0
    v_mov_b64 v[54:55], 0
    v_mov_b64 v[56:57], 0
    v_mov_b64 v[64:65], 0
    v_mov_b64 v[66:67], 0
    v_mov_b64 v[68:69], 0
    v_mov_b64 v[70:71], 0
    v_mov_b64 v[72:73], 0
    s_barrier
    s_branch L_attn
L_compute:
    s_cmp_ge_u32 s47, 2
    s_cbranch_scc1 L_compute1
    s_getpc_b64 s[78:79]
L_pc:
    s_sub_u32 s78, s78, L_pc-gated_mix__softmax_full_mha__linear_attn_block__prompt_kernel
    s_subb_u32 s79, s79, 0
    s_lshr_b32 s49, s2, 3
    s_lshl_b32 s50, s47, 5
    s_add_u32 s49, s49, s50
    s_lshl_b32 s49, s49, 10
    v_and_b32 v2, 7, v255
    v_lshl_add_u32 v2, v2, 7, s49
    v_min_u32 v2, L_codeend-gated_mix__softmax_full_mha__linear_attn_block__prompt_kernel-4, v2
    global_load_dword v253, v2, s[78:79]
    s_mov_b32 s6, 0x200000
    s_mov_b32 s7, 0x00020000
    s_mov_b32 s10, 0x180000
    s_mov_b32 s11, 0x00020000
    s_mov_b32 s42, 0x400
    s_mov_b32 s43, 0x00020000
    s_mov_b32 s14, 0x180000
    s_mov_b32 s15, 0x00020000
    s_mov_b32 s22, 0x180000
    s_mov_b32 s23, 0x00020000
    s_mov_b32 s26, 0x80000
    s_mov_b32 s27, 0x00020000
    s_mov_b32 s30, 0x80000
    s_mov_b32 s31, 0x00020000
    s_mov_b32 s34, 0x200000
    s_mov_b32 s35, 0x00020000
    s_mov_b32 s38, 0x100
    s_mov_b32 s39, 0x00020000
    s_mov_b32 s18, 0xd00000
    s_mov_b32 s19, 0x00020000
    v_and_b32 v1, 31, v255
    v_lshrrev_b32 v2, 5, v255
    v_bfe_u32 v3, v255, 1, 3
    v_xor_b32 v2, v2, v3
    v_lshlrev_b32 v1, 7, v1
    v_xor_b32 v3, 0, v2
    v_lshl_add_u32 v4, v3, 4, v1
    v_xor_b32 v3, 2, v2
    v_lshl_add_u32 v5, v3, 4, v1
    v_xor_b32 v3, 4, v2
    v_lshl_add_u32 v6, v3, 4, v1
    v_xor_b32 v3, 6, v2
    v_lshl_add_u32 v7, v3, 4, v1
    v_bfe_u32 v1, v255, 2, 2
    v_lshrrev_b32 v2, 5, v255
    v_lshl_add_u32 v1, v2, 3, v1
    v_lshlrev_b32 v8, 7, v1
    v_bfe_u32 v1, v255, 3, 1
    s_and_b32 s49, s47, 1
    v_xor_b32 v1, s49, v1
    v_bfe_u32 v2, v255, 4, 1
    v_lshl_add_u32 v1, v1, 1, v2
    v_lshlrev_b32 v1, 5, v1
    v_and_b32 v2, 3, v255
    v_lshl_add_u32 v1, v2, 3, v1
    v_add_u32 v8, v8, v1
    v_add_u32 v8, 65536, v8
    v_add_u32 v9, 65536, v8
    v_and_b32 v1, 0x33, v255
    v_bfe_u32 v2, v255, 2, 1
    v_lshl_or_b32 v1, v2, 3, v1
    v_bfe_u32 v2, v255, 3, 1
    v_lshl_or_b32 v1, v2, 2, v1
    v_lshlrev_b32 v10, 4, v1
    v_mov_b32 v144, 0x358637bd
    v_mov_b32 v145, v144
    v_mov_b64 v[146:147], v[144:145]
    v_mov_b64 v[148:149], v[144:145]
    v_mov_b64 v[150:151], v[144:145]
    v_mov_b64 v[152:153], v[144:145]
    v_mov_b64 v[154:155], v[144:145]
    v_mov_b64 v[156:157], v[144:145]
    v_mov_b64 v[158:159], v[144:145]
    v_mov_b64 v[160:161], v[144:145]
    v_mov_b64 v[162:163], v[144:145]
    v_mov_b64 v[164:165], v[144:145]
    v_mov_b64 v[166:167], v[144:145]
    v_mov_b64 v[168:169], v[144:145]
    v_mov_b64 v[170:171], v[144:145]
    v_mov_b64 v[172:173], v[144:145]
    v_mov_b64 v[174:175], v[144:145]
    s_mov_b32 s100, 0x20001
    s_mov_b32 s101, 0x20001
    v_lshrrev_b32 v11, 5, v255
    v_lshlrev_b32 v11, 4, v11
    v_add_u32 v11, 147456, v11
    s_mov_b32 s70, 0x3fb8aa3b
    s_mov_b32 s71, 0x3fb8aa3b
    s_mov_b32 s74, 0x3eb8aa3b
    s_mov_b32 s75, 0x3eb8aa3b
    s_mov_b32 s69, 0x358637bd
    v_mov_b32 v14, 0xb5c1a2a0
    v_mov_b32 v15, 0xb5c1a2a0
    v_lshlrev_b32 v248, 4, v255
    s_waitcnt lgkmcnt(0)
    v_mov_b64 v[176:177], 0
    v_mov_b64 v[178:179], 0
    v_mov_b64 v[180:181], 0
    v_mov_b64 v[182:183], 0
    v_mov_b64 v[184:185], 0
    v_mov_b64 v[186:187], 0
    v_mov_b64 v[188:189], 0
    v_mov_b64 v[190:191], 0
    v_mov_b32 v13, 0
    v_mov_b32 v12, 0
    s_cmp_eq_u32 s47, 0
    s_cbranch_scc0 L_st_7
    v_mov_b32 v2, 0
    v_mov_b32 v3, 148996
    ds_write_b32 v3, v2
    ds_write_b32 v3, v2 offset:4
    ds_write_b32 v3, v2 offset:8
    ds_write_b32 v3, v2 offset:12
    s_cmp_eq_u32 s2, 0
    s_cbranch_scc0 L_st_7
    s_memrealtime s[78:79]
    s_waitcnt lgkmcnt(0)
    s_or_b32 s78, s78, 1
    v_mov_b32 v1, s78
    buffer_store_dword v1, v2, s[36:39], 0 offen sc1
L_st_7:
    s_setprio 1
    s_barrier
    ds_read_b128 v[16:19], v4 offset:0
    ds_read_b64_tr_b16 v[24:25], v8 offset:0
    ds_read_b64_tr_b16 v[26:27], v8 offset:512
    ds_read_b128 v[20:23], v4 offset:4096
    ds_read_b128 v[28:31], v5 offset:0
    ds_read_b64_tr_b16 v[36:37], v8 offset:2048
    ds_read_b64_tr_b16 v[38:39], v8 offset:2560
    ds_read_b128 v[32:35], v5 offset:4096
    ds_read_b128 v[40:43], v6 offset:0
    ds_read_b64_tr_b16 v[48:49], v8 offset:4096
    ds_read_b64_tr_b16 v[50:51], v8 offset:4608
    ds_read_b128 v[44:47], v6 offset:4096
    ds_read_b128 v[52:55], v7 offset:0
    ds_read_b64_tr_b16 v[60:61], v8 offset:6144
    ds_read_b64_tr_b16 v[62:63], v8 offset:6656
    ds_read_b128 v[56:59], v7 offset:4096
    s_add_u32 s49, s46, 0
    s_and_b32 s49, s49, 7
    s_lshl_b32 s49, s49, 7
    v_add_u32 v0, s49, v11
    s_mov_b64 exec, s[100:101]
    ds_read_b128 v[176:179], v0
    ds_read_b128 v[180:183], v0 offset:32
    s_mov_b64 exec, -1
    v_lshlrev_b32 v248, 4, v255
    v_lshrrev_b32 v1, 5, v255
    v_and_b32 v2, 15, v255
    v_lshlrev_b32 v1, 8, v1
    v_lshl_add_u32 v1, v2, 4, v1
    v_add_u32 v249, 1024, v1
    v_mov_b32 v250, 0xdddd
    s_mov_b32 s62, 0xffff
    s_mov_b32 s63, 0xffff
    s_mov_b32 s72, 0xffff0000
    s_mov_b32 s73, 0xffff0000
    s_mov_b32 s64, 0
    s_lshl_b32 s49, s44, 2
    s_add_u32 s49, s49, s66
    s_mul_i32 s58, s49, 131072
    s_lshl_b32 s50, s67, 16
    s_add_u32 s58, s58, s50
    s_lshl_b32 s68, s45, 1
    s_add_u32 s68, s68, s67
    s_add_u32 s98, s44, 4
    s_and_b32 s98, s98, 7
    s_and_b32 s96, s2, 7
    s_lshl_b32 s96, s96, 2
    s_lshr_b32 s49, s2, 6
    s_add_u32 s96, s96, s49
    s_lshl_b32 s96, s96, 1
    s_add_u32 s96, s96, s67
    s_bfe_u32 s97, s2, 0x30003
    s_and_b32 s61, s45, 15
    s_mul_i32 s61, s61, 4096
    v_and_b32 v1, 27, v255
    v_cmp_eq_u32 vcc, 16, v1
    v_mov_b32 v2, 0
    v_mov_b32 v3, 0x3f803f80
    v_cndmask_b32 v1, v2, v3, vcc
    v_mov_b32 v192, v1
    v_mov_b32 v193, v1
    v_mov_b64 v[194:195], v[192:193]
    v_mov_b64 v[196:197], v[192:193]
    v_mov_b64 v[198:199], v[192:193]
    v_mov_b64 v[200:201], v[192:193]
    v_mov_b64 v[202:203], v[192:193]
    v_mov_b64 v[204:205], v[192:193]
    v_mov_b64 v[206:207], v[192:193]
    v_mov_b64 v[208:209], v[192:193]
    v_mov_b64 v[210:211], v[192:193]
    v_mov_b64 v[212:213], v[192:193]
    v_mov_b64 v[214:215], v[192:193]
    v_mov_b64 v[216:217], v[192:193]
    v_mov_b64 v[218:219], v[192:193]
    v_mov_b64 v[220:221], v[192:193]
    v_mov_b64 v[222:223], v[192:193]
    v_mov_b64 v[224:225], v[192:193]
    v_mov_b64 v[226:227], v[192:193]
    v_mov_b64 v[228:229], v[192:193]
    v_mov_b64 v[230:231], v[192:193]
    v_mov_b64 v[232:233], v[192:193]
    v_mov_b64 v[234:235], v[192:193]
    v_mov_b64 v[236:237], v[192:193]
    v_mov_b64 v[238:239], v[192:193]
    v_lshrrev_b32 v1, 3, v255
    v_and_b32 v2, 7, v255
    v_bfe_u32 v3, v255, 4, 1
    v_lshlrev_b32 v3, 2, v3
    v_xor_b32 v3, v3, v2
    v_lshlrev_b32 v3, 4, v3
    v_lshl_add_u32 v240, v1, 10, v3
    s_waitcnt lgkmcnt(0)
    s_barrier
    v_mfma_f32_16x16x32_bf16 v[184:187], v[176:179], v[16:19], v[184:187]
    v_mfma_f32_16x16x32_bf16 v[188:191], v[176:179], v[20:23], v[188:191]
    v_mfma_f32_16x16x32_bf16 v[184:187], v[180:183], v[28:31], v[184:187]
    v_mfma_f32_16x16x32_bf16 v[188:191], v[180:183], v[32:35], v[188:191]
    ds_read_b128 v[64:67], v4 offset:8192
    ds_read_b64_tr_b16 v[72:73], v8 offset:16384
    ds_read_b64_tr_b16 v[74:75], v8 offset:16896
    ds_read_b128 v[68:71], v4 offset:12288
    v_mfma_f32_32x32x16_bf16 v[112:127], v[24:27], v[16:19], 0
    ds_read_b128 v[76:79], v5 offset:8192
    ds_read_b64_tr_b16 v[84:85], v8 offset:18432
    ds_read_b64_tr_b16 v[86:87], v8 offset:18944
    ds_read_b128 v[80:83], v5 offset:12288
    v_mfma_f32_32x32x16_bf16 v[128:143], v[24:27], v[20:23], 0
    ds_read_b128 v[88:91], v6 offset:8192
    ds_read_b64_tr_b16 v[96:97], v8 offset:20480
    ds_read_b64_tr_b16 v[98:99], v8 offset:20992
    ds_read_b128 v[92:95], v6 offset:12288
    v_mfma_f32_32x32x16_bf16 v[112:127], v[36:39], v[28:31], v[112:127]
    ds_read_b128 v[100:103], v7 offset:8192
    ds_read_b64_tr_b16 v[108:109], v8 offset:22528
    ds_read_b64_tr_b16 v[110:111], v8 offset:23040
    ds_read_b128 v[104:107], v7 offset:12288
    v_mfma_f32_32x32x16_bf16 v[128:143], v[36:39], v[32:35], v[128:143]
    s_add_u32 s49, s46, 1
    s_and_b32 s49, s49, 7
    s_lshl_b32 s49, s49, 7
    v_add_u32 v0, s49, v11
    s_mov_b64 exec, s[100:101]
    ds_read_b128 v[176:179], v0
    ds_read_b128 v[180:183], v0 offset:32
    s_mov_b64 exec, -1
    v_mfma_f32_32x32x16_bf16 v[112:127], v[48:51], v[40:43], v[112:127]
    v_mfma_f32_32x32x16_bf16 v[128:143], v[48:51], v[44:47], v[128:143]
    v_mfma_f32_32x32x16_bf16 v[112:127], v[60:63], v[52:55], v[112:127]
    s_waitcnt lgkmcnt(0)
    s_barrier
    v_mfma_f32_32x32x16_bf16 v[128:143], v[60:63], v[56:59], v[128:143]
    v_mfma_f32_16x16x32_bf16 v[184:187], v[176:179], v[64:67], v[184:187]
    v_mfma_f32_16x16x32_bf16 v[188:191], v[176:179], v[68:71], v[188:191]
    v_mfma_f32_16x16x32_bf16 v[184:187], v[180:183], v[76:79], v[184:187]
    v_mfma_f32_16x16x32_bf16 v[188:191], v[180:183], v[80:83], v[188:191]
    ds_read_b128 v[16:19], v4 offset:16384
    ds_read_b64_tr_b16 v[24:25], v8 offset:32768
    ds_read_b64_tr_b16 v[26:27], v8 offset:33280
    ds_read_b128 v[20:23], v4 offset:20480
    v_mfma_f32_32x32x16_bf16 v[112:127], v[72:75], v[64:67], v[112:127]
    ds_read_b128 v[28:31], v5 offset:16384
    ds_read_b64_tr_b16 v[36:37], v8 offset:34816
    ds_read_b64_tr_b16 v[38:39], v8 offset:35328
    ds_read_b128 v[32:35], v5 offset:20480
    v_mfma_f32_32x32x16_bf16 v[128:143], v[72:75], v[68:71], v[128:143]
    ds_read_b128 v[40:43], v6 offset:16384
    ds_read_b64_tr_b16 v[48:49], v8 offset:36864
    ds_read_b64_tr_b16 v[50:51], v8 offset:37376
    ds_read_b128 v[44:47], v6 offset:20480
    v_mfma_f32_32x32x16_bf16 v[112:127], v[84:87], v[76:79], v[112:127]
    ds_read_b128 v[52:55], v7 offset:16384
    ds_read_b64_tr_b16 v[60:61], v8 offset:38912
    ds_read_b64_tr_b16 v[62:63], v8 offset:39424
    ds_read_b128 v[56:59], v7 offset:20480
    v_mfma_f32_32x32x16_bf16 v[128:143], v[84:87], v[80:83], v[128:143]
    s_add_u32 s49, s46, 2
    s_and_b32 s49, s49, 7
    s_lshl_b32 s49, s49, 7
    v_add_u32 v0, s49, v11
    s_mov_b64 exec, s[100:101]
    ds_read_b128 v[176:179], v0
    ds_read_b128 v[180:183], v0 offset:32
    s_mov_b64 exec, -1
    v_mfma_f32_32x32x16_bf16 v[112:127], v[96:99], v[88:91], v[112:127]
    v_mfma_f32_32x32x16_bf16 v[128:143], v[96:99], v[92:95], v[128:143]
    v_mfma_f32_32x32x16_bf16 v[112:127], v[108:111], v[100:103], v[112:127]
    s_waitcnt lgkmcnt(0)
    s_barrier
    v_mfma_f32_32x32x16_bf16 v[128:143], v[108:111], v[104:107], v[128:143]
    v_mfma_f32_16x16x32_bf16 v[184:187], v[176:179], v[16:19], v[184:187]
    v_mfma_f32_16x16x32_bf16 v[188:191], v[176:179], v[20:23], v[188:191]
    v_mfma_f32_16x16x32_bf16 v[184:187], v[180:183], v[28:31], v[184:187]
    v_mfma_f32_16x16x32_bf16 v[188:191], v[180:183], v[32:35], v[188:191]
    ds_read_b128 v[64:67], v4 offset:24576
    ds_read_b64_tr_b16 v[72:73], v8 offset:49152
    ds_read_b64_tr_b16 v[74:75], v8 offset:49664
    ds_read_b128 v[68:71], v4 offset:28672
    v_mfma_f32_32x32x16_bf16 v[112:127], v[24:27], v[16:19], v[112:127]
    ds_read_b128 v[76:79], v5 offset:24576
    ds_read_b64_tr_b16 v[84:85], v8 offset:51200
    ds_read_b64_tr_b16 v[86:87], v8 offset:51712
    ds_read_b128 v[80:83], v5 offset:28672
    v_mfma_f32_32x32x16_bf16 v[128:143], v[24:27], v[20:23], v[128:143]
    ds_read_b128 v[88:91], v6 offset:24576
    ds_read_b64_tr_b16 v[96:97], v8 offset:53248
    ds_read_b64_tr_b16 v[98:99], v8 offset:53760
    ds_read_b128 v[92:95], v6 offset:28672
    v_mfma_f32_32x32x16_bf16 v[112:127], v[36:39], v[28:31], v[112:127]
    ds_read_b128 v[100:103], v7 offset:24576
    ds_read_b64_tr_b16 v[108:109], v8 offset:55296
    ds_read_b64_tr_b16 v[110:111], v8 offset:55808
    ds_read_b128 v[104:107], v7 offset:28672
    v_mfma_f32_32x32x16_bf16 v[128:143], v[36:39], v[32:35], v[128:143]
    s_add_u32 s49, s46, 3
    s_and_b32 s49, s49, 7
    s_lshl_b32 s49, s49, 7
    v_add_u32 v0, s49, v11
    s_mov_b64 exec, s[100:101]
    ds_read_b128 v[176:179], v0
    ds_read_b128 v[180:183], v0 offset:32
    s_mov_b64 exec, -1
    v_mfma_f32_32x32x16_bf16 v[112:127], v[48:51], v[40:43], v[112:127]
    v_mfma_f32_32x32x16_bf16 v[128:143], v[48:51], v[44:47], v[128:143]
    v_mfma_f32_32x32x16_bf16 v[112:127], v[60:63], v[52:55], v[112:127]
    s_waitcnt lgkmcnt(0)
    s_barrier
    v_mfma_f32_32x32x16_bf16 v[128:143], v[60:63], v[56:59], v[128:143]
    v_mfma_f32_16x16x32_bf16 v[184:187], v[176:179], v[64:67], v[184:187]
    v_mfma_f32_16x16x32_bf16 v[188:191], v[176:179], v[68:71], v[188:191]
    v_mfma_f32_16x16x32_bf16 v[184:187], v[180:183], v[76:79], v[184:187]
    v_mfma_f32_16x16x32_bf16 v[188:191], v[180:183], v[80:83], v[188:191]
    ds_read_b128 v[16:19], v4 offset:32768
    ds_read_b64_tr_b16 v[24:25], v9 offset:0
    ds_read_b64_tr_b16 v[26:27], v9 offset:512
    ds_read_b128 v[20:23], v4 offset:36864
    v_mfma_f32_32x32x16_bf16 v[112:127], v[72:75], v[64:67], v[112:127]
    ds_read_b128 v[28:31], v5 offset:32768
    ds_read_b64_tr_b16 v[36:37], v9 offset:2048
    ds_read_b64_tr_b16 v[38:39], v9 offset:2560
    ds_read_b128 v[32:35], v5 offset:36864
    v_mfma_f32_32x32x16_bf16 v[128:143], v[72:75], v[68:71], v[128:143]
    ds_read_b128 v[40:43], v6 offset:32768
    ds_read_b64_tr_b16 v[48:49], v9 offset:4096
    ds_read_b64_tr_b16 v[50:51], v9 offset:4608
    ds_read_b128 v[44:47], v6 offset:36864
    v_mfma_f32_32x32x16_bf16 v[112:127], v[84:87], v[76:79], v[112:127]
    ds_read_b128 v[52:55], v7 offset:32768
    ds_read_b64_tr_b16 v[60:61], v9 offset:6144
    ds_read_b64_tr_b16 v[62:63], v9 offset:6656
    ds_read_b128 v[56:59], v7 offset:36864
    v_mfma_f32_32x32x16_bf16 v[128:143], v[84:87], v[80:83], v[128:143]
    s_add_u32 s49, s46, 4
    s_and_b32 s49, s49, 7
    s_lshl_b32 s49, s49, 7
    v_add_u32 v0, s49, v11
    s_mov_b64 exec, s[100:101]
    ds_read_b128 v[176:179], v0
    ds_read_b128 v[180:183], v0 offset:32
    s_mov_b64 exec, -1
    v_mfma_f32_32x32x16_bf16 v[112:127], v[96:99], v[88:91], v[112:127]
    v_mfma_f32_32x32x16_bf16 v[128:143], v[96:99], v[92:95], v[128:143]
    v_mfma_f32_32x32x16_bf16 v[112:127], v[108:111], v[100:103], v[112:127]
    s_waitcnt lgkmcnt(0)
    s_barrier
    v_mfma_f32_32x32x16_bf16 v[128:143], v[108:111], v[104:107], v[128:143]
    v_mfma_f32_16x16x32_bf16 v[184:187], v[176:179], v[16:19], v[184:187]
    v_mfma_f32_16x16x32_bf16 v[188:191], v[176:179], v[20:23], v[188:191]
    v_mfma_f32_16x16x32_bf16 v[184:187], v[180:183], v[28:31], v[184:187]
    v_mfma_f32_16x16x32_bf16 v[188:191], v[180:183], v[32:35], v[188:191]
    ds_read_b128 v[64:67], v4 offset:40960
    ds_read_b64_tr_b16 v[72:73], v8 offset:0
    ds_read_b64_tr_b16 v[74:75], v8 offset:512
    ds_read_b128 v[68:71], v4 offset:45056
    v_mfma_f32_32x32x16_bf16 v[112:127], v[24:27], v[16:19], v[112:127]
    ds_read_b128 v[76:79], v5 offset:40960
    ds_read_b64_tr_b16 v[84:85], v8 offset:2048
    ds_read_b64_tr_b16 v[86:87], v8 offset:2560
    ds_read_b128 v[80:83], v5 offset:45056
    v_mfma_f32_32x32x16_bf16 v[128:143], v[24:27], v[20:23], v[128:143]
    ds_read_b128 v[88:91], v6 offset:40960
    ds_read_b64_tr_b16 v[96:97], v8 offset:4096
    ds_read_b64_tr_b16 v[98:99], v8 offset:4608
    ds_read_b128 v[92:95], v6 offset:45056
    v_mfma_f32_32x32x16_bf16 v[112:127], v[36:39], v[28:31], v[112:127]
    ds_read_b128 v[100:103], v7 offset:40960
    ds_read_b64_tr_b16 v[108:109], v8 offset:6144
    ds_read_b64_tr_b16 v[110:111], v8 offset:6656
    ds_read_b128 v[104:107], v7 offset:45056
    v_mfma_f32_32x32x16_bf16 v[128:143], v[36:39], v[32:35], v[128:143]
    s_add_u32 s49, s46, 5
    s_and_b32 s49, s49, 7
    s_lshl_b32 s49, s49, 7
    v_add_u32 v0, s49, v11
    s_mov_b64 exec, s[100:101]
    ds_read_b128 v[176:179], v0
    ds_read_b128 v[180:183], v0 offset:32
    s_mov_b64 exec, -1
    v_mfma_f32_32x32x16_bf16 v[112:127], v[48:51], v[40:43], v[112:127]
    v_mfma_f32_32x32x16_bf16 v[128:143], v[48:51], v[44:47], v[128:143]
    v_mfma_f32_32x32x16_bf16 v[112:127], v[60:63], v[52:55], v[112:127]
    s_waitcnt lgkmcnt(0)
    s_barrier
    v_mfma_f32_32x32x16_bf16 v[128:143], v[60:63], v[56:59], v[128:143]
    v_mfma_f32_16x16x32_bf16 v[184:187], v[176:179], v[64:67], v[184:187]
    v_mfma_f32_16x16x32_bf16 v[188:191], v[176:179], v[68:71], v[188:191]
    v_mfma_f32_16x16x32_bf16 v[184:187], v[180:183], v[76:79], v[184:187]
    v_mfma_f32_16x16x32_bf16 v[188:191], v[180:183], v[80:83], v[188:191]
    ds_read_b128 v[16:19], v4 offset:49152
    ds_read_b64_tr_b16 v[24:25], v8 offset:16384
    ds_read_b64_tr_b16 v[26:27], v8 offset:16896
    ds_read_b128 v[20:23], v4 offset:53248
    v_mfma_f32_32x32x16_bf16 v[112:127], v[72:75], v[64:67], v[112:127]
    ds_read_b128 v[28:31], v5 offset:49152
    ds_read_b64_tr_b16 v[36:37], v8 offset:18432
    ds_read_b64_tr_b16 v[38:39], v8 offset:18944
    ds_read_b128 v[32:35], v5 offset:53248
    v_mfma_f32_32x32x16_bf16 v[128:143], v[72:75], v[68:71], v[128:143]
    ds_read_b128 v[40:43], v6 offset:49152
    ds_read_b64_tr_b16 v[48:49], v8 offset:20480
    ds_read_b64_tr_b16 v[50:51], v8 offset:20992
    ds_read_b128 v[44:47], v6 offset:53248
    v_mfma_f32_32x32x16_bf16 v[112:127], v[84:87], v[76:79], v[112:127]
    ds_read_b128 v[52:55], v7 offset:49152
    ds_read_b64_tr_b16 v[60:61], v8 offset:22528
    ds_read_b64_tr_b16 v[62:63], v8 offset:23040
    ds_read_b128 v[56:59], v7 offset:53248
    v_mfma_f32_32x32x16_bf16 v[128:143], v[84:87], v[80:83], v[128:143]
    s_add_u32 s49, s46, 6
    s_and_b32 s49, s49, 7
    s_lshl_b32 s49, s49, 7
    v_add_u32 v0, s49, v11
    s_mov_b64 exec, s[100:101]
    ds_read_b128 v[176:179], v0
    ds_read_b128 v[180:183], v0 offset:32
    s_mov_b64 exec, -1
    v_mfma_f32_32x32x16_bf16 v[112:127], v[96:99], v[88:91], v[112:127]
    v_mfma_f32_32x32x16_bf16 v[128:143], v[96:99], v[92:95], v[128:143]
    v_mfma_f32_32x32x16_bf16 v[112:127], v[108:111], v[100:103], v[112:127]
    s_waitcnt lgkmcnt(0)
    s_barrier
    v_mfma_f32_32x32x16_bf16 v[128:143], v[108:111], v[104:107], v[128:143]
    v_mfma_f32_16x16x32_bf16 v[184:187], v[176:179], v[16:19], v[184:187]
    v_mfma_f32_16x16x32_bf16 v[188:191], v[176:179], v[20:23], v[188:191]
    v_mfma_f32_16x16x32_bf16 v[184:187], v[180:183], v[28:31], v[184:187]
    v_mfma_f32_16x16x32_bf16 v[188:191], v[180:183], v[32:35], v[188:191]
    ds_read_b128 v[64:67], v4 offset:57344
    ds_read_b64_tr_b16 v[72:73], v8 offset:32768
    ds_read_b64_tr_b16 v[74:75], v8 offset:33280
    ds_read_b128 v[68:71], v4 offset:61440
    v_mfma_f32_32x32x16_bf16 v[112:127], v[24:27], v[16:19], v[112:127]
    ds_read_b128 v[76:79], v5 offset:57344
    ds_read_b64_tr_b16 v[84:85], v8 offset:34816
    ds_read_b64_tr_b16 v[86:87], v8 offset:35328
    ds_read_b128 v[80:83], v5 offset:61440
    v_mfma_f32_32x32x16_bf16 v[128:143], v[24:27], v[20:23], v[128:143]
    ds_read_b128 v[88:91], v6 offset:57344
    ds_read_b64_tr_b16 v[96:97], v8 offset:36864
    ds_read_b64_tr_b16 v[98:99], v8 offset:37376
    ds_read_b128 v[92:95], v6 offset:61440
    v_mfma_f32_32x32x16_bf16 v[112:127], v[36:39], v[28:31], v[112:127]
    ds_read_b128 v[100:103], v7 offset:57344
    ds_read_b64_tr_b16 v[108:109], v8 offset:38912
    ds_read_b64_tr_b16 v[110:111], v8 offset:39424
    ds_read_b128 v[104:107], v7 offset:61440
    v_mfma_f32_32x32x16_bf16 v[128:143], v[36:39], v[32:35], v[128:143]
    s_add_u32 s49, s46, 7
    s_and_b32 s49, s49, 7
    s_lshl_b32 s49, s49, 7
    v_add_u32 v0, s49, v11
    s_mov_b64 exec, s[100:101]
    ds_read_b128 v[176:179], v0
    ds_read_b128 v[180:183], v0 offset:32
    s_mov_b64 exec, -1
    v_mfma_f32_32x32x16_bf16 v[112:127], v[48:51], v[40:43], v[112:127]
    v_mfma_f32_32x32x16_bf16 v[128:143], v[48:51], v[44:47], v[128:143]
    v_mfma_f32_32x32x16_bf16 v[112:127], v[60:63], v[52:55], v[112:127]
    s_waitcnt lgkmcnt(0)
    s_barrier
    v_mfma_f32_32x32x16_bf16 v[128:143], v[60:63], v[56:59], v[128:143]
    v_mfma_f32_16x16x32_bf16 v[184:187], v[176:179], v[64:67], v[184:187]
    v_mfma_f32_16x16x32_bf16 v[188:191], v[176:179], v[68:71], v[188:191]
    v_mfma_f32_16x16x32_bf16 v[184:187], v[180:183], v[76:79], v[184:187]
    v_mfma_f32_16x16x32_bf16 v[188:191], v[180:183], v[80:83], v[188:191]
    ds_read_b128 v[16:19], v4 offset:0
    ds_read_b64_tr_b16 v[24:25], v8 offset:49152
    ds_read_b64_tr_b16 v[26:27], v8 offset:49664
    v_mfma_f32_32x32x16_bf16 v[112:127], v[72:75], v[64:67], v[112:127]
    ds_read_b128 v[20:23], v4 offset:4096
    ds_read_b64_tr_b16 v[28:29], v8 offset:53248
    ds_read_b64_tr_b16 v[30:31], v8 offset:53760
    v_mfma_f32_32x32x16_bf16 v[128:143], v[72:75], v[68:71], v[128:143]
    ds_read_b128 v[32:35], v5 offset:0
    ds_read_b64_tr_b16 v[40:41], v8 offset:51200
    ds_read_b64_tr_b16 v[42:43], v8 offset:51712
    v_mfma_f32_32x32x16_bf16 v[112:127], v[84:87], v[76:79], v[112:127]
    ds_read_b128 v[36:39], v5 offset:4096
    ds_read_b64_tr_b16 v[44:45], v8 offset:55296
    ds_read_b64_tr_b16 v[46:47], v8 offset:55808
    v_mfma_f32_32x32x16_bf16 v[128:143], v[84:87], v[80:83], v[128:143]
    v_mfma_f32_32x32x16_bf16 v[112:127], v[96:99], v[88:91], v[112:127]
    v_mfma_f32_32x32x16_bf16 v[128:143], v[96:99], v[92:95], v[128:143]
    v_mfma_f32_32x32x16_bf16 v[112:127], v[108:111], v[100:103], v[112:127]
    buffer_load_dword v12, v13, s[36:39], 0 offen sc1
    s_waitcnt lgkmcnt(0)
    s_barrier
    v_mfma_f32_32x32x16_bf16 v[128:143], v[108:111], v[104:107], v[128:143]
    v_mov_b32 v0, v184
    v_mov_b32 v11, v185
    v_mov_b32 v2, v188
    v_mov_b32 v3, v189
    ds_read_b128 v[64:67], v6 offset:0
    ds_read_b64_tr_b16 v[72:73], v9 offset:0
    ds_read_b64_tr_b16 v[74:75], v9 offset:512
    v_mfma_f32_32x32x16_bf16 v[144:159], v[16:19], v[24:27], v[144:159]
    ds_read_b128 v[68:71], v6 offset:4096
    ds_read_b64_tr_b16 v[76:77], v9 offset:4096
    ds_read_b64_tr_b16 v[78:79], v9 offset:4608
    v_mfma_f32_32x32x16_bf16 v[160:175], v[20:23], v[24:27], v[160:175]
    ds_read_b128 v[80:83], v7 offset:0
    ds_read_b64_tr_b16 v[88:89], v9 offset:2048
    ds_read_b64_tr_b16 v[90:91], v9 offset:2560
    v_mfma_f32_32x32x16_bf16 v[48:63], v[16:19], v[28:31], 0
    ds_read_b128 v[84:87], v7 offset:4096
    ds_read_b64_tr_b16 v[92:93], v9 offset:6144
    ds_read_b64_tr_b16 v[94:95], v9 offset:6656
    v_mfma_f32_32x32x16_bf16 v[96:111], v[20:23], v[28:31], 0
    s_add_u32 s49, s44, 1
    s_and_b32 s49, s49, 7
    s_lshl_b32 s49, s49, 2
    s_and_b32 s50, s47, 1
    s_lshl_b32 s50, s50, 1
    s_add_u32 s49, s49, s50
    s_mul_i32 s49, s49, 131072
    s_lshl_b32 s50, s45, 12
    s_add_u32 s49, s49, s50
    s_add_u32 s50, s49, 131072
    s_mov_b32 s53, s49
    s_mov_b32 s54, s50
    v_mul_f32 v112, s74, v112
    v_mul_f32 v113, s74, v113
    v_mul_f32 v114, s74, v114
    v_mul_f32 v115, s74, v115
    v_mfma_f32_32x32x16_bf16 v[144:159], v[32:35], v[40:43], v[144:159]
    v_mul_f32 v116, s74, v116
    v_mul_f32 v117, s74, v117
    v_mul_f32 v118, s74, v118
    v_mul_f32 v119, s74, v119
    v_cvt_pk_bf16_f32 v176, v112, v113
    v_cvt_pk_bf16_f32 v177, v114, v115
    v_cvt_pk_bf16_f32 v178, v116, v117
    v_cvt_pk_bf16_f32 v179, v118, v119
    buffer_store_dwordx4 v[176:179], v10, s[16:19], s53 offen offset:0 sc1
    v_mul_f32 v120, s74, v120
    v_mul_f32 v121, s74, v121
    v_mul_f32 v122, s74, v122
    v_mul_f32 v123, s74, v123
    v_mul_f32 v124, s74, v124
    v_mul_f32 v125, s74, v125
    v_mul_f32 v126, s74, v126
    v_mfma_f32_32x32x16_bf16 v[160:175], v[36:39], v[40:43], v[160:175]
    v_mul_f32 v127, s74, v127
    v_cvt_pk_bf16_f32 v180, v120, v121
    v_cvt_pk_bf16_f32 v181, v122, v123
    v_cvt_pk_bf16_f32 v182, v124, v125
    v_cvt_pk_bf16_f32 v183, v126, v127
    buffer_store_dwordx4 v[180:183], v10, s[16:19], s54 offen offset:0 sc1
    v_mul_f32 v128, s74, v128
    v_mul_f32 v129, s74, v129
    v_mul_f32 v130, s74, v130
    v_mul_f32 v131, s74, v131
    v_mul_f32 v132, s74, v132
    v_mul_f32 v133, s74, v133
    v_mul_f32 v134, s74, v134
    v_mul_f32 v135, s74, v135
    v_cvt_pk_bf16_f32 v184, v128, v129
    v_cvt_pk_bf16_f32 v185, v130, v131
    v_mfma_f32_32x32x16_bf16 v[48:63], v[32:35], v[44:47], v[48:63]
    v_cvt_pk_bf16_f32 v186, v132, v133
    v_cvt_pk_bf16_f32 v187, v134, v135
    buffer_store_dwordx4 v[184:187], v10, s[16:19], s53 offen offset:2048 sc1
    v_mul_f32 v136, s74, v136
    v_mul_f32 v137, s74, v137
    v_mul_f32 v138, s74, v138
    v_mul_f32 v139, s74, v139
    v_mul_f32 v140, s74, v140
    v_mul_f32 v141, s74, v141
    v_mul_f32 v142, s74, v142
    v_mul_f32 v143, s74, v143
    v_cvt_pk_bf16_f32 v188, v136, v137
    v_cvt_pk_bf16_f32 v189, v138, v139
    v_cvt_pk_bf16_f32 v190, v140, v141
    v_cvt_pk_bf16_f32 v191, v142, v143
    buffer_store_dwordx4 v[188:191], v10, s[16:19], s54 offen offset:2048 sc1
    s_waitcnt lgkmcnt(0)
    s_barrier
    v_mfma_f32_32x32x16_bf16 v[96:111], v[36:39], v[44:47], v[96:111]
    ds_read_b128 v[16:19], v4 offset:8192
    ds_read_b64_tr_b16 v[24:25], v8 offset:0
    ds_read_b64_tr_b16 v[26:27], v8 offset:512
    v_mfma_f32_32x32x16_bf16 v[144:159], v[64:67], v[72:75], v[144:159]
    ds_read_b128 v[20:23], v4 offset:12288
    ds_read_b64_tr_b16 v[28:29], v8 offset:4096
    ds_read_b64_tr_b16 v[30:31], v8 offset:4608
    v_mfma_f32_32x32x16_bf16 v[160:175], v[68:71], v[72:75], v[160:175]
    ds_read_b128 v[32:35], v5 offset:8192
    ds_read_b64_tr_b16 v[40:41], v8 offset:2048
    ds_read_b64_tr_b16 v[42:43], v8 offset:2560
    v_mfma_f32_32x32x16_bf16 v[48:63], v[64:67], v[76:79], v[48:63]
    ds_read_b128 v[36:39], v5 offset:12288
    ds_read_b64_tr_b16 v[44:45], v8 offset:6144
    ds_read_b64_tr_b16 v[46:47], v8 offset:6656
    v_mfma_f32_32x32x16_bf16 v[96:111], v[68:71], v[76:79], v[96:111]
    v_mfma_f32_32x32x16_bf16 v[144:159], v[80:83], v[88:91], v[144:159]
    v_mfma_f32_32x32x16_bf16 v[160:175], v[84:87], v[88:91], v[160:175]
    v_mfma_f32_32x32x16_bf16 v[48:63], v[80:83], v[92:95], v[48:63]
    s_waitcnt lgkmcnt(0)
    s_barrier
    v_mfma_f32_32x32x16_bf16 v[96:111], v[84:87], v[92:95], v[96:111]
    ds_read_b128 v[64:67], v6 offset:8192
    ds_read_b64_tr_b16 v[72:73], v8 offset:16384
    ds_read_b64_tr_b16 v[74:75], v8 offset:16896
    v_mfma_f32_32x32x16_bf16 v[144:159], v[16:19], v[24:27], v[144:159]
    ds_read_b128 v[68:71], v6 offset:12288
    ds_read_b64_tr_b16 v[76:77], v8 offset:20480
    ds_read_b64_tr_b16 v[78:79], v8 offset:20992
    v_mfma_f32_32x32x16_bf16 v[160:175], v[20:23], v[24:27], v[160:175]
    ds_read_b128 v[80:83], v7 offset:8192
    ds_read_b64_tr_b16 v[88:89], v8 offset:18432
    ds_read_b64_tr_b16 v[90:91], v8 offset:18944
    v_mfma_f32_32x32x16_bf16 v[48:63], v[16:19], v[28:31], v[48:63]
    ds_read_b128 v[84:87], v7 offset:12288
    ds_read_b64_tr_b16 v[92:93], v8 offset:22528
    ds_read_b64_tr_b16 v[94:95], v8 offset:23040
    v_mfma_f32_32x32x16_bf16 v[96:111], v[20:23], v[28:31], v[96:111]
    v_mfma_f32_32x32x16_bf16 v[144:159], v[32:35], v[40:43], v[144:159]
    v_mfma_f32_32x32x16_bf16 v[160:175], v[36:39], v[40:43], v[160:175]
    v_mfma_f32_32x32x16_bf16 v[48:63], v[32:35], v[44:47], v[48:63]
    s_waitcnt lgkmcnt(0)
    s_barrier
    v_mfma_f32_32x32x16_bf16 v[96:111], v[36:39], v[44:47], v[96:111]
    ds_read_b128 v[16:19], v4 offset:16384
    ds_read_b64_tr_b16 v[24:25], v8 offset:32768
    ds_read_b64_tr_b16 v[26:27], v8 offset:33280
    v_mfma_f32_32x32x16_bf16 v[144:159], v[64:67], v[72:75], v[144:159]
    ds_read_b128 v[20:23], v4 offset:20480
    ds_read_b64_tr_b16 v[28:29], v8 offset:36864
    ds_read_b64_tr_b16 v[30:31], v8 offset:37376
    v_mfma_f32_32x32x16_bf16 v[160:175], v[68:71], v[72:75], v[160:175]
    ds_read_b128 v[32:35], v5 offset:16384
    ds_read_b64_tr_b16 v[40:41], v8 offset:34816
    ds_read_b64_tr_b16 v[42:43], v8 offset:35328
    v_mfma_f32_32x32x16_bf16 v[48:63], v[64:67], v[76:79], v[48:63]
    ds_read_b128 v[36:39], v5 offset:20480
    ds_read_b64_tr_b16 v[44:45], v8 offset:38912
    ds_read_b64_tr_b16 v[46:47], v8 offset:39424
    v_mfma_f32_32x32x16_bf16 v[96:111], v[68:71], v[76:79], v[96:111]
    v_mfma_f32_32x32x16_bf16 v[144:159], v[80:83], v[88:91], v[144:159]
    v_mfma_f32_32x32x16_bf16 v[160:175], v[84:87], v[88:91], v[160:175]
    v_mfma_f32_32x32x16_bf16 v[48:63], v[80:83], v[92:95], v[48:63]
    s_waitcnt lgkmcnt(0)
    s_barrier
    v_mfma_f32_32x32x16_bf16 v[96:111], v[84:87], v[92:95], v[96:111]
    ds_read_b128 v[64:67], v6 offset:16384
    ds_read_b64_tr_b16 v[72:73], v8 offset:49152
    ds_read_b64_tr_b16 v[74:75], v8 offset:49664
    v_mfma_f32_32x32x16_bf16 v[144:159], v[16:19], v[24:27], v[144:159]
    ds_read_b128 v[68:71], v6 offset:20480
    ds_read_b64_tr_b16 v[76:77], v8 offset:53248
    ds_read_b64_tr_b16 v[78:79], v8 offset:53760
    v_mfma_f32_32x32x16_bf16 v[160:175], v[20:23], v[24:27], v[160:175]
    ds_read_b128 v[80:83], v7 offset:16384
    ds_read_b64_tr_b16 v[88:89], v8 offset:51200
    ds_read_b64_tr_b16 v[90:91], v8 offset:51712
    v_mfma_f32_32x32x16_bf16 v[48:63], v[16:19], v[28:31], v[48:63]
    ds_read_b128 v[84:87], v7 offset:20480
    ds_read_b64_tr_b16 v[92:93], v8 offset:55296
    ds_read_b64_tr_b16 v[94:95], v8 offset:55808
    v_mfma_f32_32x32x16_bf16 v[96:111], v[20:23], v[28:31], v[96:111]
    v_mfma_f32_32x32x16_bf16 v[144:159], v[32:35], v[40:43], v[144:159]
    v_mfma_f32_32x32x16_bf16 v[160:175], v[36:39], v[40:43], v[160:175]
    v_mfma_f32_32x32x16_bf16 v[48:63], v[32:35], v[44:47], v[48:63]
    s_waitcnt lgkmcnt(0)
    s_waitcnt vmcnt(0)
    s_mov_b32 s65, 100000
L_np_10:
    v_readfirstlane_b32 s48, v12
    s_sub_u32 s65, s65, 1
    s_cbranch_scc1 L_nn_9
    s_cmp_lg_u32 s48, 0
    s_cbranch_scc1 L_nn_9
    buffer_load_dword v12, v13, s[36:39], 0 offen sc1
    s_waitcnt vmcnt(0)
    s_branch L_np_10
L_nn_9:
    s_barrier
    v_mfma_f32_32x32x16_bf16 v[96:111], v[36:39], v[44:47], v[96:111]
    ds_read_b128 v[16:19], v4 offset:24576
    ds_read_b64_tr_b16 v[24:25], v9 offset:0
    ds_read_b64_tr_b16 v[26:27], v9 offset:512
    v_mfma_f32_32x32x16_bf16 v[144:159], v[64:67], v[72:75], v[144:159]
    ds_read_b128 v[20:23], v4 offset:28672
    ds_read_b64_tr_b16 v[28:29], v9 offset:4096
    ds_read_b64_tr_b16 v[30:31], v9 offset:4608
    v_mfma_f32_32x32x16_bf16 v[160:175], v[68:71], v[72:75], v[160:175]
    ds_read_b128 v[32:35], v5 offset:24576
    ds_read_b64_tr_b16 v[40:41], v9 offset:2048
    ds_read_b64_tr_b16 v[42:43], v9 offset:2560
    v_mfma_f32_32x32x16_bf16 v[48:63], v[64:67], v[76:79], v[48:63]
    ds_read_b128 v[36:39], v5 offset:28672
    ds_read_b64_tr_b16 v[44:45], v9 offset:6144
    ds_read_b64_tr_b16 v[46:47], v9 offset:6656
    v_mfma_f32_32x32x16_bf16 v[96:111], v[68:71], v[76:79], v[96:111]
    v_mfma_f32_32x32x16_bf16 v[144:159], v[80:83], v[88:91], v[144:159]
    v_mfma_f32_32x32x16_bf16 v[160:175], v[84:87], v[88:91], v[160:175]
    v_mfma_f32_32x32x16_bf16 v[48:63], v[80:83], v[92:95], v[48:63]
    s_cmp_eq_u32 s47, 0
    s_cbranch_scc0 L_kf_11
    s_lshl_b32 s49, s44, 5
    s_add_u32 s49, s49, s45
    s_lshl_b32 s49, s49, 7
    s_add_u32 s49, s49, 9437184
    s_mov_b64 exec, 1
    buffer_store_dword v12, v13, s[16:19], s49 offen sc1
    s_mov_b64 exec, -1
L_kf_11:
    s_waitcnt lgkmcnt(0)
    s_barrier
    v_mfma_f32_32x32x16_bf16 v[96:111], v[84:87], v[92:95], v[96:111]
    ds_read_b128 v[64:67], v6 offset:24576
    ds_read_b64_tr_b16 v[72:73], v8 offset:0
    ds_read_b64_tr_b16 v[74:75], v8 offset:512
    v_mfma_f32_32x32x16_bf16 v[144:159], v[16:19], v[24:27], v[144:159]
    ds_read_b128 v[68:71], v6 offset:28672
    ds_read_b64_tr_b16 v[76:77], v8 offset:4096
    ds_read_b64_tr_b16 v[78:79], v8 offset:4608
    v_mfma_f32_32x32x16_bf16 v[160:175], v[20:23], v[24:27], v[160:175]
    ds_read_b128 v[80:83], v7 offset:24576
    ds_read_b64_tr_b16 v[88:89], v8 offset:2048
    ds_read_b64_tr_b16 v[90:91], v8 offset:2560
    v_mfma_f32_32x32x16_bf16 v[48:63], v[16:19], v[28:31], v[48:63]
    ds_read_b128 v[84:87], v7 offset:28672
    ds_read_b64_tr_b16 v[92:93], v8 offset:6144
    ds_read_b64_tr_b16 v[94:95], v8 offset:6656
    v_mfma_f32_32x32x16_bf16 v[96:111], v[20:23], v[28:31], v[96:111]
    v_mfma_f32_32x32x16_bf16 v[144:159], v[32:35], v[40:43], v[144:159]
    v_mfma_f32_32x32x16_bf16 v[160:175], v[36:39], v[40:43], v[160:175]
    v_mfma_f32_32x32x16_bf16 v[48:63], v[32:35], v[44:47], v[48:63]
    s_waitcnt lgkmcnt(0)
    s_barrier
    v_mfma_f32_32x32x16_bf16 v[96:111], v[36:39], v[44:47], v[96:111]
    ds_read_b128 v[16:19], v4 offset:32768
    ds_read_b64_tr_b16 v[24:25], v8 offset:16384
    ds_read_b64_tr_b16 v[26:27], v8 offset:16896
    v_mfma_f32_32x32x16_bf16 v[144:159], v[64:67], v[72:75], v[144:159]
    ds_read_b128 v[20:23], v4 offset:36864
    ds_read_b64_tr_b16 v[28:29], v8 offset:20480
    ds_read_b64_tr_b16 v[30:31], v8 offset:20992
    v_mfma_f32_32x32x16_bf16 v[160:175], v[68:71], v[72:75], v[160:175]
    ds_read_b128 v[32:35], v5 offset:32768
    ds_read_b64_tr_b16 v[40:41], v8 offset:18432
    ds_read_b64_tr_b16 v[42:43], v8 offset:18944
    v_mfma_f32_32x32x16_bf16 v[48:63], v[64:67], v[76:79], v[48:63]
    ds_read_b128 v[36:39], v5 offset:36864
    ds_read_b64_tr_b16 v[44:45], v8 offset:22528
    ds_read_b64_tr_b16 v[46:47], v8 offset:23040
    v_mfma_f32_32x32x16_bf16 v[96:111], v[68:71], v[76:79], v[96:111]
    v_mfma_f32_32x32x16_bf16 v[144:159], v[80:83], v[88:91], v[144:159]
    v_mfma_f32_32x32x16_bf16 v[160:175], v[84:87], v[88:91], v[160:175]
    v_mfma_f32_32x32x16_bf16 v[48:63], v[80:83], v[92:95], v[48:63]
    s_waitcnt lgkmcnt(0)
    s_barrier
    v_mfma_f32_32x32x16_bf16 v[96:111], v[84:87], v[92:95], v[96:111]
    ds_read_b128 v[64:67], v6 offset:32768
    ds_read_b64_tr_b16 v[72:73], v8 offset:32768
    ds_read_b64_tr_b16 v[74:75], v8 offset:33280
    v_mfma_f32_32x32x16_bf16 v[144:159], v[16:19], v[24:27], v[144:159]
    ds_read_b128 v[68:71], v6 offset:36864
    ds_read_b64_tr_b16 v[76:77], v8 offset:36864
    ds_read_b64_tr_b16 v[78:79], v8 offset:37376
    v_mfma_f32_32x32x16_bf16 v[160:175], v[20:23], v[24:27], v[160:175]
    ds_read_b128 v[80:83], v7 offset:32768
    ds_read_b64_tr_b16 v[88:89], v8 offset:34816
    ds_read_b64_tr_b16 v[90:91], v8 offset:35328
    v_mfma_f32_32x32x16_bf16 v[48:63], v[16:19], v[28:31], v[48:63]
    ds_read_b128 v[84:87], v7 offset:36864
    ds_read_b64_tr_b16 v[92:93], v8 offset:38912
    ds_read_b64_tr_b16 v[94:95], v8 offset:39424
    v_mfma_f32_32x32x16_bf16 v[96:111], v[20:23], v[28:31], v[96:111]
    v_mfma_f32_32x32x16_bf16 v[144:159], v[32:35], v[40:43], v[144:159]
    v_mfma_f32_32x32x16_bf16 v[160:175], v[36:39], v[40:43], v[160:175]
    v_mfma_f32_32x32x16_bf16 v[48:63], v[32:35], v[44:47], v[48:63]
    s_waitcnt lgkmcnt(0)
    s_barrier
    v_mfma_f32_32x32x16_bf16 v[96:111], v[36:39], v[44:47], v[96:111]
    ds_read_b128 v[16:19], v4 offset:40960
    ds_read_b64_tr_b16 v[24:25], v8 offset:49152
    ds_read_b64_tr_b16 v[26:27], v8 offset:49664
    v_mfma_f32_32x32x16_bf16 v[144:159], v[64:67], v[72:75], v[144:159]
    ds_read_b128 v[20:23], v4 offset:45056
    ds_read_b64_tr_b16 v[28:29], v8 offset:53248
    ds_read_b64_tr_b16 v[30:31], v8 offset:53760
    v_mfma_f32_32x32x16_bf16 v[160:175], v[68:71], v[72:75], v[160:175]
    ds_read_b128 v[32:35], v5 offset:40960
    ds_read_b64_tr_b16 v[40:41], v8 offset:51200
    ds_read_b64_tr_b16 v[42:43], v8 offset:51712
    v_mfma_f32_32x32x16_bf16 v[48:63], v[64:67], v[76:79], v[48:63]
    ds_read_b128 v[36:39], v5 offset:45056
    ds_read_b64_tr_b16 v[44:45], v8 offset:55296
    ds_read_b64_tr_b16 v[46:47], v8 offset:55808
    v_mfma_f32_32x32x16_bf16 v[96:111], v[68:71], v[76:79], v[96:111]
    v_mfma_f32_32x32x16_bf16 v[144:159], v[80:83], v[88:91], v[144:159]
    v_mfma_f32_32x32x16_bf16 v[160:175], v[84:87], v[88:91], v[160:175]
    v_mfma_f32_32x32x16_bf16 v[48:63], v[80:83], v[92:95], v[48:63]
    s_waitcnt lgkmcnt(0)
    s_barrier
    v_mfma_f32_32x32x16_bf16 v[96:111], v[84:87], v[92:95], v[96:111]
    ds_read_b128 v[64:67], v6 offset:40960
    ds_read_b64_tr_b16 v[72:73], v9 offset:0
    ds_read_b64_tr_b16 v[74:75], v9 offset:512
    v_mfma_f32_32x32x16_bf16 v[144:159], v[16:19], v[24:27], v[144:159]
    ds_read_b128 v[68:71], v6 offset:45056
    ds_read_b64_tr_b16 v[76:77], v9 offset:4096
    ds_read_b64_tr_b16 v[78:79], v9 offset:4608
    v_mfma_f32_32x32x16_bf16 v[160:175], v[20:23], v[24:27], v[160:175]
    ds_read_b128 v[80:83], v7 offset:40960
    ds_read_b64_tr_b16 v[88:89], v9 offset:2048
    ds_read_b64_tr_b16 v[90:91], v9 offset:2560
    v_mfma_f32_32x32x16_bf16 v[48:63], v[16:19], v[28:31], v[48:63]
    ds_read_b128 v[84:87], v7 offset:45056
    ds_read_b64_tr_b16 v[92:93], v9 offset:6144
    ds_read_b64_tr_b16 v[94:95], v9 offset:6656
    v_mfma_f32_32x32x16_bf16 v[96:111], v[20:23], v[28:31], v[96:111]
    v_mfma_f32_32x32x16_bf16 v[144:159], v[32:35], v[40:43], v[144:159]
    v_mfma_f32_32x32x16_bf16 v[160:175], v[36:39], v[40:43], v[160:175]
    v_mfma_f32_32x32x16_bf16 v[48:63], v[32:35], v[44:47], v[48:63]
    s_waitcnt lgkmcnt(0)
    s_barrier
    v_mfma_f32_32x32x16_bf16 v[96:111], v[36:39], v[44:47], v[96:111]
    ds_read_b128 v[16:19], v4 offset:49152
    ds_read_b64_tr_b16 v[24:25], v8 offset:0
    ds_read_b64_tr_b16 v[26:27], v8 offset:512
    v_mfma_f32_32x32x16_bf16 v[144:159], v[64:67], v[72:75], v[144:159]
    ds_read_b128 v[20:23], v4 offset:53248
    ds_read_b64_tr_b16 v[28:29], v8 offset:4096
    ds_read_b64_tr_b16 v[30:31], v8 offset:4608
    v_mfma_f32_32x32x16_bf16 v[160:175], v[68:71], v[72:75], v[160:175]
    ds_read_b128 v[32:35], v5 offset:49152
    ds_read_b64_tr_b16 v[40:41], v8 offset:2048
    ds_read_b64_tr_b16 v[42:43], v8 offset:2560
    v_mfma_f32_32x32x16_bf16 v[48:63], v[64:67], v[76:79], v[48:63]
    ds_read_b128 v[36:39], v5 offset:53248
    ds_read_b64_tr_b16 v[44:45], v8 offset:6144
    ds_read_b64_tr_b16 v[46:47], v8 offset:6656
    v_mfma_f32_32x32x16_bf16 v[96:111], v[68:71], v[76:79], v[96:111]
    v_mfma_f32_32x32x16_bf16 v[144:159], v[80:83], v[88:91], v[144:159]
    v_mfma_f32_32x32x16_bf16 v[160:175], v[84:87], v[88:91], v[160:175]
    v_mfma_f32_32x32x16_bf16 v[48:63], v[80:83], v[92:95], v[48:63]
    s_waitcnt lgkmcnt(0)
    s_barrier
    v_mfma_f32_32x32x16_bf16 v[96:111], v[84:87], v[92:95], v[96:111]
    ds_read_b128 v[64:67], v6 offset:49152
    ds_read_b64_tr_b16 v[72:73], v8 offset:16384
    ds_read_b64_tr_b16 v[74:75], v8 offset:16896
    v_mfma_f32_32x32x16_bf16 v[144:159], v[16:19], v[24:27], v[144:159]
    ds_read_b128 v[68:71], v6 offset:53248
    ds_read_b64_tr_b16 v[76:77], v8 offset:20480
    ds_read_b64_tr_b16 v[78:79], v8 offset:20992
    v_mfma_f32_32x32x16_bf16 v[160:175], v[20:23], v[24:27], v[160:175]
    ds_read_b128 v[80:83], v7 offset:49152
    ds_read_b64_tr_b16 v[88:89], v8 offset:18432
    ds_read_b64_tr_b16 v[90:91], v8 offset:18944
    v_mfma_f32_32x32x16_bf16 v[48:63], v[16:19], v[28:31], v[48:63]
    ds_read_b128 v[84:87], v7 offset:53248
    ds_read_b64_tr_b16 v[92:93], v8 offset:22528
    ds_read_b64_tr_b16 v[94:95], v8 offset:23040
    v_mfma_f32_32x32x16_bf16 v[96:111], v[20:23], v[28:31], v[96:111]
    v_mfma_f32_32x32x16_bf16 v[144:159], v[32:35], v[40:43], v[144:159]
    v_mfma_f32_32x32x16_bf16 v[160:175], v[36:39], v[40:43], v[160:175]
    v_mfma_f32_32x32x16_bf16 v[48:63], v[32:35], v[44:47], v[48:63]
    s_waitcnt lgkmcnt(0)
    s_barrier
    v_mfma_f32_32x32x16_bf16 v[96:111], v[36:39], v[44:47], v[96:111]
    ds_read_b128 v[16:19], v4 offset:57344
    ds_read_b64_tr_b16 v[24:25], v8 offset:32768
    ds_read_b64_tr_b16 v[26:27], v8 offset:33280
    v_mfma_f32_32x32x16_bf16 v[144:159], v[64:67], v[72:75], v[144:159]
    ds_read_b128 v[20:23], v4 offset:61440
    ds_read_b64_tr_b16 v[28:29], v8 offset:36864
    ds_read_b64_tr_b16 v[30:31], v8 offset:37376
    v_mfma_f32_32x32x16_bf16 v[160:175], v[68:71], v[72:75], v[160:175]
    ds_read_b128 v[32:35], v5 offset:57344
    ds_read_b64_tr_b16 v[40:41], v8 offset:34816
    ds_read_b64_tr_b16 v[42:43], v8 offset:35328
    v_mfma_f32_32x32x16_bf16 v[48:63], v[64:67], v[76:79], v[48:63]
    ds_read_b128 v[36:39], v5 offset:61440
    ds_read_b64_tr_b16 v[44:45], v8 offset:38912
    ds_read_b64_tr_b16 v[46:47], v8 offset:39424
    v_mfma_f32_32x32x16_bf16 v[96:111], v[68:71], v[76:79], v[96:111]
    v_mfma_f32_32x32x16_bf16 v[144:159], v[80:83], v[88:91], v[144:159]
    v_mfma_f32_32x32x16_bf16 v[160:175], v[84:87], v[88:91], v[160:175]
    v_mfma_f32_32x32x16_bf16 v[48:63], v[80:83], v[92:95], v[48:63]
    s_waitcnt lgkmcnt(0)
    s_barrier
    v_mfma_f32_32x32x16_bf16 v[96:111], v[84:87], v[92:95], v[96:111]
    ds_read_b128 v[64:67], v6 offset:57344
    ds_read_b64_tr_b16 v[72:73], v8 offset:49152
    ds_read_b64_tr_b16 v[74:75], v8 offset:49664
    v_mfma_f32_32x32x16_bf16 v[144:159], v[16:19], v[24:27], v[144:159]
    ds_read_b128 v[68:71], v6 offset:61440
    ds_read_b64_tr_b16 v[76:77], v8 offset:53248
    ds_read_b64_tr_b16 v[78:79], v8 offset:53760
    v_mfma_f32_32x32x16_bf16 v[160:175], v[20:23], v[24:27], v[160:175]
    ds_read_b128 v[80:83], v7 offset:57344
    ds_read_b64_tr_b16 v[88:89], v8 offset:51200
    ds_read_b64_tr_b16 v[90:91], v8 offset:51712
    v_mfma_f32_32x32x16_bf16 v[48:63], v[16:19], v[28:31], v[48:63]
    ds_read_b128 v[84:87], v7 offset:61440
    ds_read_b64_tr_b16 v[92:93], v8 offset:55296
    ds_read_b64_tr_b16 v[94:95], v8 offset:55808
    v_mfma_f32_32x32x16_bf16 v[96:111], v[20:23], v[28:31], v[96:111]
    v_mfma_f32_32x32x16_bf16 v[144:159], v[32:35], v[40:43], v[144:159]
    v_mfma_f32_32x32x16_bf16 v[160:175], v[36:39], v[40:43], v[160:175]
    v_mfma_f32_32x32x16_bf16 v[48:63], v[32:35], v[44:47], v[48:63]
    s_waitcnt lgkmcnt(0)
    v_mfma_f32_32x32x16_bf16 v[96:111], v[36:39], v[44:47], v[96:111]
    v_mfma_f32_32x32x16_bf16 v[144:159], v[64:67], v[72:75], v[144:159]
    v_mfma_f32_32x32x16_bf16 v[160:175], v[68:71], v[72:75], v[160:175]
    v_mfma_f32_32x32x16_bf16 v[144:159], v[80:83], v[88:91], v[144:159]
    s_barrier
    s_setprio 0
    v_mfma_f32_32x32x16_bf16 v[160:175], v[84:87], v[88:91], v[160:175]
    v_lshlrev_b32 v4, 2, v255
    v_add_u32 v4, 148480, v4
    s_mov_b64 exec, 0xffff
    ds_write_b32 v4, v0
    ds_write_b32 v4, v11 offset:64
    ds_write_b32 v4, v2 offset:128
    ds_write_b32 v4, v3 offset:192
    s_mov_b64 exec, -1
    v_mfma_f32_32x32x16_bf16 v[48:63], v[64:67], v[76:79], v[48:63]
    v_mfma_f32_32x32x16_bf16 v[96:111], v[68:71], v[76:79], v[96:111]
    v_mfma_f32_32x32x16_bf16 v[48:63], v[80:83], v[92:95], v[48:63]
    v_mfma_f32_32x32x16_bf16 v[96:111], v[84:87], v[92:95], v[96:111]
    s_mov_b32 s59, s61
    s_add_u32 s60, s59, s58
    s_mov_b64 exec, s[62:63]
    buffer_load_dwordx4 v[192:195], v249, s[16:19], s60 offen sc1
    s_mov_b64 exec, -1
    buffer_load_dwordx4 v[112:115], v248, s[16:19], s60 offen sc1
    s_mov_b64 exec, s[62:63]
    buffer_load_dwordx4 v[216:219], v249, s[16:19], s60 offen offset:512 sc1
    s_add_u32 s59, s59, 2048
    s_and_b32 s59, s59, 0xffff
    s_add_u32 s60, s59, s58
    buffer_load_dwordx4 v[196:199], v249, s[16:19], s60 offen sc1
    s_mov_b64 exec, -1
    buffer_load_dwordx4 v[116:119], v248, s[16:19], s60 offen sc1
    v_cvt_pk_bf16_f32 v32, v48, v49
    v_cvt_pk_bf16_f32 v33, v50, v51
    v_cvt_pk_bf16_f32 v34, v52, v53
    v_cvt_pk_bf16_f32 v35, v54, v55
    v_cvt_pk_bf16_f32 v36, v56, v57
    v_cvt_pk_bf16_f32 v37, v58, v59
    v_cvt_pk_bf16_f32 v38, v60, v61
    v_cvt_pk_bf16_f32 v39, v62, v63
    v_cvt_pk_bf16_f32 v40, v96, v97
    v_cvt_pk_bf16_f32 v41, v98, v99
    v_cvt_pk_bf16_f32 v42, v100, v101
    v_cvt_pk_bf16_f32 v43, v102, v103
    v_cvt_pk_bf16_f32 v44, v104, v105
    v_cvt_pk_bf16_f32 v45, v106, v107
    v_cvt_pk_bf16_f32 v46, v108, v109
    v_cvt_pk_bf16_f32 v47, v110, v111
    v_mov_b32 v140, 0x3f803f80
    v_mov_b32 v141, 0x3f803f80
    v_mov_b32 v142, 0x3f803f80
    v_mov_b32 v143, 0x3f803f80
    v_pk_fma_f32 v[176:177], v[144:145], s[70:71], v[14:15]
    v_pk_fma_f32 v[178:179], v[146:147], s[70:71], v[14:15]
    v_pk_fma_f32 v[180:181], v[148:149], s[70:71], v[14:15]
    v_pk_fma_f32 v[182:183], v[150:151], s[70:71], v[14:15]
    v_exp_f32_e64 v176, v176 clamp
    v_exp_f32_e64 v177, v177 clamp
    v_exp_f32_e64 v178, v178 clamp
    v_exp_f32_e64 v179, v179 clamp
    v_exp_f32_e64 v180, v180 clamp
    v_exp_f32_e64 v181, v181 clamp
    v_exp_f32_e64 v182, v182 clamp
    v_exp_f32_e64 v183, v183 clamp
    v_max_f32 v144, s69, v144
    v_max_f32 v145, s69, v145
    v_max_f32 v146, s69, v146
    v_max_f32 v147, s69, v147
    v_max_f32 v148, s69, v148
    v_max_f32 v149, s69, v149
    v_max_f32 v150, s69, v150
    v_max_f32 v151, s69, v151
    v_pk_add_f32 v[144:145], v[176:177], v[144:145]
    v_pk_add_f32 v[146:147], v[178:179], v[146:147]
    v_pk_add_f32 v[148:149], v[180:181], v[148:149]
    v_pk_add_f32 v[150:151], v[182:183], v[150:151]
    v_pk_fma_f32 v[176:177], v[152:153], s[70:71], v[14:15]
    v_pk_fma_f32 v[178:179], v[154:155], s[70:71], v[14:15]
    v_pk_fma_f32 v[180:181], v[156:157], s[70:71], v[14:15]
    v_pk_fma_f32 v[182:183], v[158:159], s[70:71], v[14:15]
    v_exp_f32_e64 v176, v176 clamp
    v_exp_f32_e64 v177, v177 clamp
    v_exp_f32_e64 v178, v178 clamp
    v_exp_f32_e64 v179, v179 clamp
    v_exp_f32_e64 v180, v180 clamp
    v_exp_f32_e64 v181, v181 clamp
    v_exp_f32_e64 v182, v182 clamp
    v_exp_f32_e64 v183, v183 clamp
    v_max_f32 v152, s69, v152
    v_max_f32 v153, s69, v153
    v_max_f32 v154, s69, v154
    v_max_f32 v155, s69, v155
    v_max_f32 v156, s69, v156
    v_max_f32 v157, s69, v157
    v_max_f32 v158, s69, v158
    v_max_f32 v159, s69, v159
    v_pk_add_f32 v[152:153], v[176:177], v[152:153]
    v_pk_add_f32 v[154:155], v[178:179], v[154:155]
    v_pk_add_f32 v[156:157], v[180:181], v[156:157]
    v_pk_add_f32 v[158:159], v[182:183], v[158:159]
    v_cvt_pk_bf16_f32 v16, v144, v145
    v_cvt_pk_bf16_f32 v17, v146, v147
    v_cvt_pk_bf16_f32 v18, v148, v149
    v_cvt_pk_bf16_f32 v19, v150, v151
    v_cvt_pk_bf16_f32 v20, v152, v153
    v_cvt_pk_bf16_f32 v21, v154, v155
    v_cvt_pk_bf16_f32 v22, v156, v157
    v_cvt_pk_bf16_f32 v23, v158, v159
    s_nop 1
    v_mfma_f32_32x32x16_bf16 v[64:79], v[16:19], v[32:35], 0
    v_mfma_f32_32x32x16_bf16 v[80:95], v[140:143], v[16:19], 0
    v_mfma_f32_32x32x16_bf16 v[64:79], v[20:23], v[36:39], v[64:79]
    v_mfma_f32_32x32x16_bf16 v[80:95], v[140:143], v[20:23], v[80:95]
    v_pk_fma_f32 v[176:177], v[160:161], s[70:71], v[14:15]
    v_pk_fma_f32 v[178:179], v[162:163], s[70:71], v[14:15]
    v_pk_fma_f32 v[180:181], v[164:165], s[70:71], v[14:15]
    v_pk_fma_f32 v[182:183], v[166:167], s[70:71], v[14:15]
    v_exp_f32_e64 v176, v176 clamp
    v_exp_f32_e64 v177, v177 clamp
    v_exp_f32_e64 v178, v178 clamp
    v_exp_f32_e64 v179, v179 clamp
    v_exp_f32_e64 v180, v180 clamp
    v_exp_f32_e64 v181, v181 clamp
    v_exp_f32_e64 v182, v182 clamp
    v_exp_f32_e64 v183, v183 clamp
    v_max_f32 v160, s69, v160
    v_max_f32 v161, s69, v161
    v_max_f32 v162, s69, v162
    v_max_f32 v163, s69, v163
    v_max_f32 v164, s69, v164
    v_max_f32 v165, s69, v165
    v_max_f32 v166, s69, v166
    v_max_f32 v167, s69, v167
    v_pk_add_f32 v[160:161], v[176:177], v[160:161]
    v_pk_add_f32 v[162:163], v[178:179], v[162:163]
    v_pk_add_f32 v[164:165], v[180:181], v[164:165]
    v_pk_add_f32 v[166:167], v[182:183], v[166:167]
    v_pk_fma_f32 v[176:177], v[168:169], s[70:71], v[14:15]
    v_pk_fma_f32 v[178:179], v[170:171], s[70:71], v[14:15]
    v_pk_fma_f32 v[180:181], v[172:173], s[70:71], v[14:15]
    v_pk_fma_f32 v[182:183], v[174:175], s[70:71], v[14:15]
    v_exp_f32_e64 v176, v176 clamp
    v_exp_f32_e64 v177, v177 clamp
    v_exp_f32_e64 v178, v178 clamp
    v_exp_f32_e64 v179, v179 clamp
    v_exp_f32_e64 v180, v180 clamp
    v_exp_f32_e64 v181, v181 clamp
    v_exp_f32_e64 v182, v182 clamp
    v_exp_f32_e64 v183, v183 clamp
    v_max_f32 v168, s69, v168
    v_max_f32 v169, s69, v169
    v_max_f32 v170, s69, v170
    v_max_f32 v171, s69, v171
    v_max_f32 v172, s69, v172
    v_max_f32 v173, s69, v173
    v_max_f32 v174, s69, v174
    v_max_f32 v175, s69, v175
    v_pk_add_f32 v[168:169], v[176:177], v[168:169]
    v_pk_add_f32 v[170:171], v[178:179], v[170:171]
    v_pk_add_f32 v[172:173], v[180:181], v[172:173]
    v_pk_add_f32 v[174:175], v[182:183], v[174:175]
    v_cvt_pk_bf16_f32 v24, v160, v161
    v_cvt_pk_bf16_f32 v25, v162, v163
    v_cvt_pk_bf16_f32 v26, v164, v165
    v_cvt_pk_bf16_f32 v27, v166, v167
    v_cvt_pk_bf16_f32 v28, v168, v169
    v_cvt_pk_bf16_f32 v29, v170, v171
    v_cvt_pk_bf16_f32 v30, v172, v173
    v_cvt_pk_bf16_f32 v31, v174, v175
    s_nop 1
    v_mfma_f32_32x32x16_bf16 v[64:79], v[24:27], v[40:43], v[64:79]
    v_mfma_f32_32x32x16_bf16 v[80:95], v[140:143], v[24:27], v[80:95]
    v_mfma_f32_32x32x16_bf16 v[64:79], v[28:31], v[44:47], v[64:79]
    v_mfma_f32_32x32x16_bf16 v[80:95], v[140:143], v[28:31], v[80:95]
    s_nop 10
    v_cndmask_b32 v144, v64, v72, s[72:73]
    v_cndmask_b32 v145, v65, v73, s[72:73]
    v_cndmask_b32 v146, v66, v74, s[72:73]
    v_cndmask_b32 v147, v67, v75, s[72:73]
    v_cndmask_b32 v148, v68, v76, s[72:73]
    v_cndmask_b32 v149, v69, v77, s[72:73]
    v_cndmask_b32 v150, v70, v78, s[72:73]
    v_cndmask_b32 v151, v71, v79, s[72:73]
    v_mov_b32 v152, v80
    v_mov_b64 v[48:49], 0
    v_mov_b64 v[50:51], 0
    v_mov_b64 v[52:53], 0
    v_mov_b64 v[54:55], 0
    v_mov_b64 v[56:57], 0
    v_mov_b64 v[64:65], 0
    v_mov_b64 v[66:67], 0
    v_mov_b64 v[68:69], 0
    v_mov_b64 v[70:71], 0
    v_mov_b64 v[72:73], 0
    v_mov_b32 v1, 149000
    v_mov_b32 v2, 1
    s_waitcnt lgkmcnt(0)
    s_mov_b64 exec, 1
    ds_add_u32 v1, v2
    s_mov_b64 exec, -1
    s_branch L_attn
L_compute1:
    s_mov_b32 s6, 0x200000
    s_mov_b32 s7, 0x00020000
    s_mov_b32 s10, 0x180000
    s_mov_b32 s11, 0x00020000
    s_mov_b32 s42, 0x400
    s_mov_b32 s43, 0x00020000
    s_mov_b32 s14, 0x180000
    s_mov_b32 s15, 0x00020000
    s_mov_b32 s22, 0x180000
    s_mov_b32 s23, 0x00020000
    s_mov_b32 s26, 0x80000
    s_mov_b32 s27, 0x00020000
    s_mov_b32 s30, 0x80000
    s_mov_b32 s31, 0x00020000
    s_mov_b32 s34, 0x200000
    s_mov_b32 s35, 0x00020000
    s_mov_b32 s38, 0x100
    s_mov_b32 s39, 0x00020000
    s_mov_b32 s18, 0xd00000
    s_mov_b32 s19, 0x00020000
    v_and_b32 v1, 31, v255
    v_lshrrev_b32 v2, 5, v255
    v_bfe_u32 v3, v255, 1, 3
    v_xor_b32 v2, v2, v3
    v_lshlrev_b32 v1, 7, v1
    v_xor_b32 v3, 0, v2
    v_lshl_add_u32 v4, v3, 4, v1
    v_xor_b32 v3, 2, v2
    v_lshl_add_u32 v5, v3, 4, v1
    v_xor_b32 v3, 4, v2
    v_lshl_add_u32 v6, v3, 4, v1
    v_xor_b32 v3, 6, v2
    v_lshl_add_u32 v7, v3, 4, v1
    v_bfe_u32 v1, v255, 2, 2
    v_lshrrev_b32 v2, 5, v255
    v_lshl_add_u32 v1, v2, 3, v1
    v_lshlrev_b32 v8, 7, v1
    v_bfe_u32 v1, v255, 3, 1
    s_and_b32 s49, s47, 1
    v_xor_b32 v1, s49, v1
    v_bfe_u32 v2, v255, 4, 1
    v_lshl_add_u32 v1, v1, 1, v2
    v_lshlrev_b32 v1, 5, v1
    v_and_b32 v2, 3, v255
    v_lshl_add_u32 v1, v2, 3, v1
    v_add_u32 v8, v8, v1
    v_add_u32 v8, 65536, v8
    v_add_u32 v9, 65536, v8
    v_bfe_u32 v1, v255, 4, 1
    v_mul_u32_u24 v1, 131072, v1
    v_lshrrev_b32 v2, 5, v255
    v_lshl_add_u32 v1, v2, 8, v1
    v_and_b32 v2, 15, v255
    v_lshl_add_u32 v1, v2, 4, v1
    v_add_u32 v10, 1024, v1
    v_mov_b32 v144, 0x358637bd
    v_mov_b32 v145, v144
    v_mov_b64 v[146:147], v[144:145]
    v_mov_b64 v[148:149], v[144:145]
    v_mov_b64 v[150:151], v[144:145]
    v_mov_b64 v[152:153], v[144:145]
    v_mov_b64 v[154:155], v[144:145]
    v_mov_b64 v[156:157], v[144:145]
    v_mov_b64 v[158:159], v[144:145]
    v_mov_b64 v[160:161], v[144:145]
    v_mov_b64 v[162:163], v[144:145]
    v_mov_b64 v[164:165], v[144:145]
    v_mov_b64 v[166:167], v[144:145]
    v_mov_b64 v[168:169], v[144:145]
    v_mov_b64 v[170:171], v[144:145]
    v_mov_b64 v[172:173], v[144:145]
    v_mov_b64 v[174:175], v[144:145]
    s_mov_b32 s100, 0x20001
    s_mov_b32 s101, 0x20001
    v_lshrrev_b32 v11, 5, v255
    v_lshlrev_b32 v11, 4, v11
    v_add_u32 v11, 147520, v11
    s_mov_b32 s70, 0x3fb8aa3b
    s_mov_b32 s71, 0x3fb8aa3b
    s_mov_b32 s74, 0x3eb8aa3b
    s_mov_b32 s75, 0x3eb8aa3b
    s_mov_b32 s69, 0x358637bd
    v_mov_b32 v14, 0xb5c1a2a0
    v_mov_b32 v15, 0xb5c1a2a0
    v_lshlrev_b32 v248, 4, v255
    s_waitcnt lgkmcnt(0)
    v_mov_b64 v[176:177], 0
    v_mov_b64 v[178:179], 0
    v_mov_b64 v[180:181], 0
    v_mov_b64 v[182:183], 0
    v_mov_b64 v[184:185], 0
    v_mov_b64 v[186:187], 0
    v_mov_b64 v[188:189], 0
    v_mov_b64 v[190:191], 0
    v_mov_b32 v13, 0
    v_mov_b32 v12, 0
    s_cmp_eq_u32 s47, 3
    s_cbranch_scc0 L_st_13
    s_cmp_lt_u32 s45, 4
    s_cbranch_scc0 L_st_13
    s_add_u32 s49, s44, 5
    s_and_b32 s49, s49, 7
    s_lshl_b32 s49, s49, 2
    s_add_u32 s49, s49, s45
    s_mul_i32 s49, s49, 2048
    s_add_u32 s49, s49, 11534336
    s_add_u32 s50, s49, 1024
    v_and_b32 v20, 0x70, v248
    v_lshrrev_b32 v21, 3, v255
    v_mul_u32_u24 v21, 128, v21
    v_add_u32 v21, v21, v20
    v_mov_b32 v16, 0
    v_mov_b32 v17, 0
    v_mov_b32 v18, 0
    v_mov_b32 v19, 0
    buffer_store_dwordx4 v[16:19], v21, s[16:19], s49 offen sc1
    buffer_store_dwordx4 v[16:19], v20, s[16:19], s50 offen sc1
L_st_13:
    s_setprio 1
    s_barrier
    ds_read_b128 v[16:19], v4 offset:0
    ds_read_b64_tr_b16 v[24:25], v8 offset:8192
    ds_read_b64_tr_b16 v[26:27], v8 offset:8704
    ds_read_b128 v[20:23], v4 offset:4096
    ds_read_b128 v[28:31], v5 offset:0
    ds_read_b64_tr_b16 v[36:37], v8 offset:10240
    ds_read_b64_tr_b16 v[38:39], v8 offset:10752
    ds_read_b128 v[32:35], v5 offset:4096
    ds_read_b128 v[40:43], v6 offset:0
    ds_read_b64_tr_b16 v[48:49], v8 offset:12288
    ds_read_b64_tr_b16 v[50:51], v8 offset:12800
    ds_read_b128 v[44:47], v6 offset:4096
    ds_read_b128 v[52:55], v7 offset:0
    ds_read_b64_tr_b16 v[60:61], v8 offset:14336
    ds_read_b64_tr_b16 v[62:63], v8 offset:14848
    ds_read_b128 v[56:59], v7 offset:4096
    s_add_u32 s49, s46, 0
    s_and_b32 s49, s49, 7
    s_lshl_b32 s49, s49, 7
    v_add_u32 v0, s49, v11
    s_mov_b64 exec, s[100:101]
    ds_read_b128 v[176:179], v0
    ds_read_b128 v[180:183], v0 offset:32
    s_mov_b64 exec, -1
    v_lshlrev_b32 v248, 4, v255
    v_lshrrev_b32 v1, 5, v255
    v_and_b32 v2, 15, v255
    v_lshlrev_b32 v1, 8, v1
    v_lshl_add_u32 v1, v2, 4, v1
    v_add_u32 v249, 1024, v1
    v_mov_b32 v250, 0xdddd
    s_mov_b32 s62, 0xffff
    s_mov_b32 s63, 0xffff
    s_mov_b32 s72, 0xffff0000
    s_mov_b32 s73, 0xffff0000
    s_mov_b32 s64, 0
    s_lshl_b32 s49, s44, 2
    s_add_u32 s49, s49, s66
    s_mul_i32 s58, s49, 131072
    s_lshl_b32 s50, s67, 16
    s_add_u32 s58, s58, s50
    s_lshl_b32 s68, s45, 1
    s_add_u32 s68, s68, s67
    s_add_u32 s98, s44, 4
    s_and_b32 s98, s98, 7
    s_and_b32 s96, s2, 7
    s_lshl_b32 s96, s96, 2
    s_lshr_b32 s49, s2, 6
    s_add_u32 s96, s96, s49
    s_lshl_b32 s96, s96, 1
    s_add_u32 s96, s96, s67
    s_bfe_u32 s97, s2, 0x30003
    s_and_b32 s61, s45, 15
    s_mul_i32 s61, s61, 4096
    v_and_b32 v1, 27, v255
    v_cmp_eq_u32 vcc, 16, v1
    v_mov_b32 v2, 0
    v_mov_b32 v3, 0x3f803f80
    v_cndmask_b32 v1, v2, v3, vcc
    v_mov_b32 v192, v1
    v_mov_b32 v193, v1
    v_mov_b64 v[194:195], v[192:193]
    v_mov_b64 v[196:197], v[192:193]
    v_mov_b64 v[198:199], v[192:193]
    v_mov_b64 v[200:201], v[192:193]
    v_mov_b64 v[202:203], v[192:193]
    v_mov_b64 v[204:205], v[192:193]
    v_mov_b64 v[206:207], v[192:193]
    v_mov_b64 v[208:209], v[192:193]
    v_mov_b64 v[210:211], v[192:193]
    v_mov_b64 v[212:213], v[192:193]
    v_mov_b64 v[214:215], v[192:193]
    v_mov_b64 v[216:217], v[192:193]
    v_mov_b64 v[218:219], v[192:193]
    v_mov_b64 v[220:221], v[192:193]
    v_mov_b64 v[222:223], v[192:193]
    v_mov_b64 v[224:225], v[192:193]
    v_mov_b64 v[226:227], v[192:193]
    v_mov_b64 v[228:229], v[192:193]
    v_mov_b64 v[230:231], v[192:193]
    v_mov_b64 v[232:233], v[192:193]
    v_mov_b64 v[234:235], v[192:193]
    v_mov_b64 v[236:237], v[192:193]
    v_mov_b64 v[238:239], v[192:193]
    v_lshrrev_b32 v1, 3, v255
    v_and_b32 v2, 7, v255
    v_bfe_u32 v3, v255, 4, 1
    v_lshlrev_b32 v3, 2, v3
    v_xor_b32 v3, v3, v2
    v_lshlrev_b32 v3, 4, v3
    v_lshl_add_u32 v240, v1, 10, v3
    s_waitcnt lgkmcnt(0)
    s_barrier
    v_mfma_f32_16x16x32_bf16 v[184:187], v[176:179], v[40:43], v[184:187]
    v_mfma_f32_16x16x32_bf16 v[188:191], v[176:179], v[44:47], v[188:191]
    v_mfma_f32_16x16x32_bf16 v[184:187], v[180:183], v[52:55], v[184:187]
    v_mfma_f32_16x16x32_bf16 v[188:191], v[180:183], v[56:59], v[188:191]
    ds_read_b128 v[64:67], v4 offset:8192
    ds_read_b64_tr_b16 v[72:73], v8 offset:24576
    ds_read_b64_tr_b16 v[74:75], v8 offset:25088
    ds_read_b128 v[68:71], v4 offset:12288
    v_mfma_f32_32x32x16_bf16 v[112:127], v[16:19], v[24:27], 0
    ds_read_b128 v[76:79], v5 offset:8192
    ds_read_b64_tr_b16 v[84:85], v8 offset:26624
    ds_read_b64_tr_b16 v[86:87], v8 offset:27136
    ds_read_b128 v[80:83], v5 offset:12288
    v_mfma_f32_32x32x16_bf16 v[128:143], v[20:23], v[24:27], 0
    ds_read_b128 v[88:91], v6 offset:8192
    ds_read_b64_tr_b16 v[96:97], v8 offset:28672
    ds_read_b64_tr_b16 v[98:99], v8 offset:29184
    ds_read_b128 v[92:95], v6 offset:12288
    v_mfma_f32_32x32x16_bf16 v[112:127], v[28:31], v[36:39], v[112:127]
    ds_read_b128 v[100:103], v7 offset:8192
    ds_read_b64_tr_b16 v[108:109], v8 offset:30720
    ds_read_b64_tr_b16 v[110:111], v8 offset:31232
    ds_read_b128 v[104:107], v7 offset:12288
    v_mfma_f32_32x32x16_bf16 v[128:143], v[32:35], v[36:39], v[128:143]
    s_add_u32 s49, s46, 1
    s_and_b32 s49, s49, 7
    s_lshl_b32 s49, s49, 7
    v_add_u32 v0, s49, v11
    s_mov_b64 exec, s[100:101]
    ds_read_b128 v[176:179], v0
    ds_read_b128 v[180:183], v0 offset:32
    s_mov_b64 exec, -1
    v_mfma_f32_32x32x16_bf16 v[112:127], v[40:43], v[48:51], v[112:127]
    v_mfma_f32_32x32x16_bf16 v[128:143], v[44:47], v[48:51], v[128:143]
    v_mfma_f32_32x32x16_bf16 v[112:127], v[52:55], v[60:63], v[112:127]
    s_waitcnt lgkmcnt(0)
    s_barrier
    v_mfma_f32_32x32x16_bf16 v[128:143], v[56:59], v[60:63], v[128:143]
    v_mfma_f32_16x16x32_bf16 v[184:187], v[176:179], v[88:91], v[184:187]
    v_mfma_f32_16x16x32_bf16 v[188:191], v[176:179], v[92:95], v[188:191]
    v_mfma_f32_16x16x32_bf16 v[184:187], v[180:183], v[100:103], v[184:187]
    v_mfma_f32_16x16x32_bf16 v[188:191], v[180:183], v[104:107], v[188:191]
    ds_read_b128 v[16:19], v4 offset:16384
    ds_read_b64_tr_b16 v[24:25], v8 offset:40960
    ds_read_b64_tr_b16 v[26:27], v8 offset:41472
    ds_read_b128 v[20:23], v4 offset:20480
    v_mfma_f32_32x32x16_bf16 v[112:127], v[64:67], v[72:75], v[112:127]
    ds_read_b128 v[28:31], v5 offset:16384
    ds_read_b64_tr_b16 v[36:37], v8 offset:43008
    ds_read_b64_tr_b16 v[38:39], v8 offset:43520
    ds_read_b128 v[32:35], v5 offset:20480
    v_mfma_f32_32x32x16_bf16 v[128:143], v[68:71], v[72:75], v[128:143]
    ds_read_b128 v[40:43], v6 offset:16384
    ds_read_b64_tr_b16 v[48:49], v8 offset:45056
    ds_read_b64_tr_b16 v[50:51], v8 offset:45568
    ds_read_b128 v[44:47], v6 offset:20480
    v_mfma_f32_32x32x16_bf16 v[112:127], v[76:79], v[84:87], v[112:127]
    ds_read_b128 v[52:55], v7 offset:16384
    ds_read_b64_tr_b16 v[60:61], v8 offset:47104
    ds_read_b64_tr_b16 v[62:63], v8 offset:47616
    ds_read_b128 v[56:59], v7 offset:20480
    v_mfma_f32_32x32x16_bf16 v[128:143], v[80:83], v[84:87], v[128:143]
    s_add_u32 s49, s46, 2
    s_and_b32 s49, s49, 7
    s_lshl_b32 s49, s49, 7
    v_add_u32 v0, s49, v11
    s_mov_b64 exec, s[100:101]
    ds_read_b128 v[176:179], v0
    ds_read_b128 v[180:183], v0 offset:32
    s_mov_b64 exec, -1
    v_mfma_f32_32x32x16_bf16 v[112:127], v[88:91], v[96:99], v[112:127]
    v_mfma_f32_32x32x16_bf16 v[128:143], v[92:95], v[96:99], v[128:143]
    v_mfma_f32_32x32x16_bf16 v[112:127], v[100:103], v[108:111], v[112:127]
    s_waitcnt lgkmcnt(0)
    s_barrier
    v_mfma_f32_32x32x16_bf16 v[128:143], v[104:107], v[108:111], v[128:143]
    v_mfma_f32_16x16x32_bf16 v[184:187], v[176:179], v[40:43], v[184:187]
    v_mfma_f32_16x16x32_bf16 v[188:191], v[176:179], v[44:47], v[188:191]
    v_mfma_f32_16x16x32_bf16 v[184:187], v[180:183], v[52:55], v[184:187]
    v_mfma_f32_16x16x32_bf16 v[188:191], v[180:183], v[56:59], v[188:191]
    ds_read_b128 v[64:67], v4 offset:24576
    ds_read_b64_tr_b16 v[72:73], v8 offset:57344
    ds_read_b64_tr_b16 v[74:75], v8 offset:57856
    ds_read_b128 v[68:71], v4 offset:28672
    v_mfma_f32_32x32x16_bf16 v[112:127], v[16:19], v[24:27], v[112:127]
    ds_read_b128 v[76:79], v5 offset:24576
    ds_read_b64_tr_b16 v[84:85], v8 offset:59392
    ds_read_b64_tr_b16 v[86:87], v8 offset:59904
    ds_read_b128 v[80:83], v5 offset:28672
    v_mfma_f32_32x32x16_bf16 v[128:143], v[20:23], v[24:27], v[128:143]
    ds_read_b128 v[88:91], v6 offset:24576
    ds_read_b64_tr_b16 v[96:97], v8 offset:61440
    ds_read_b64_tr_b16 v[98:99], v8 offset:61952
    ds_read_b128 v[92:95], v6 offset:28672
    v_mfma_f32_32x32x16_bf16 v[112:127], v[28:31], v[36:39], v[112:127]
    ds_read_b128 v[100:103], v7 offset:24576
    ds_read_b64_tr_b16 v[108:109], v8 offset:63488
    ds_read_b64_tr_b16 v[110:111], v8 offset:64000
    ds_read_b128 v[104:107], v7 offset:28672
    v_mfma_f32_32x32x16_bf16 v[128:143], v[32:35], v[36:39], v[128:143]
    s_add_u32 s49, s46, 3
    s_and_b32 s49, s49, 7
    s_lshl_b32 s49, s49, 7
    v_add_u32 v0, s49, v11
    s_mov_b64 exec, s[100:101]
    ds_read_b128 v[176:179], v0
    ds_read_b128 v[180:183], v0 offset:32
    s_mov_b64 exec, -1
    v_mfma_f32_32x32x16_bf16 v[112:127], v[40:43], v[48:51], v[112:127]
    v_mfma_f32_32x32x16_bf16 v[128:143], v[44:47], v[48:51], v[128:143]
    v_mfma_f32_32x32x16_bf16 v[112:127], v[52:55], v[60:63], v[112:127]
    s_waitcnt lgkmcnt(0)
    s_barrier
    v_mfma_f32_32x32x16_bf16 v[128:143], v[56:59], v[60:63], v[128:143]
    v_mfma_f32_16x16x32_bf16 v[184:187], v[176:179], v[88:91], v[184:187]
    v_mfma_f32_16x16x32_bf16 v[188:191], v[176:179], v[92:95], v[188:191]
    v_mfma_f32_16x16x32_bf16 v[184:187], v[180:183], v[100:103], v[184:187]
    v_mfma_f32_16x16x32_bf16 v[188:191], v[180:183], v[104:107], v[188:191]
    ds_read_b128 v[16:19], v4 offset:32768
    ds_read_b64_tr_b16 v[24:25], v9 offset:8192
    ds_read_b64_tr_b16 v[26:27], v9 offset:8704
    ds_read_b128 v[20:23], v4 offset:36864
    v_mfma_f32_32x32x16_bf16 v[112:127], v[64:67], v[72:75], v[112:127]
    ds_read_b128 v[28:31], v5 offset:32768
    ds_read_b64_tr_b16 v[36:37], v9 offset:10240
    ds_read_b64_tr_b16 v[38:39], v9 offset:10752
    ds_read_b128 v[32:35], v5 offset:36864
    v_mfma_f32_32x32x16_bf16 v[128:143], v[68:71], v[72:75], v[128:143]
    ds_read_b128 v[40:43], v6 offset:32768
    ds_read_b64_tr_b16 v[48:49], v9 offset:12288
    ds_read_b64_tr_b16 v[50:51], v9 offset:12800
    ds_read_b128 v[44:47], v6 offset:36864
    v_mfma_f32_32x32x16_bf16 v[112:127], v[76:79], v[84:87], v[112:127]
    ds_read_b128 v[52:55], v7 offset:32768
    ds_read_b64_tr_b16 v[60:61], v9 offset:14336
    ds_read_b64_tr_b16 v[62:63], v9 offset:14848
    ds_read_b128 v[56:59], v7 offset:36864
    v_mfma_f32_32x32x16_bf16 v[128:143], v[80:83], v[84:87], v[128:143]
    s_add_u32 s49, s46, 4
    s_and_b32 s49, s49, 7
    s_lshl_b32 s49, s49, 7
    v_add_u32 v0, s49, v11
    s_mov_b64 exec, s[100:101]
    ds_read_b128 v[176:179], v0
    ds_read_b128 v[180:183], v0 offset:32
    s_mov_b64 exec, -1
    v_mfma_f32_32x32x16_bf16 v[112:127], v[88:91], v[96:99], v[112:127]
    v_mfma_f32_32x32x16_bf16 v[128:143], v[92:95], v[96:99], v[128:143]
    v_mfma_f32_32x32x16_bf16 v[112:127], v[100:103], v[108:111], v[112:127]
    s_waitcnt lgkmcnt(0)
    s_barrier
    v_mfma_f32_32x32x16_bf16 v[128:143], v[104:107], v[108:111], v[128:143]
    v_mfma_f32_16x16x32_bf16 v[184:187], v[176:179], v[40:43], v[184:187]
    v_mfma_f32_16x16x32_bf16 v[188:191], v[176:179], v[44:47], v[188:191]
    v_mfma_f32_16x16x32_bf16 v[184:187], v[180:183], v[52:55], v[184:187]
    v_mfma_f32_16x16x32_bf16 v[188:191], v[180:183], v[56:59], v[188:191]
    ds_read_b128 v[64:67], v4 offset:40960
    ds_read_b64_tr_b16 v[72:73], v8 offset:8192
    ds_read_b64_tr_b16 v[74:75], v8 offset:8704
    ds_read_b128 v[68:71], v4 offset:45056
    v_mfma_f32_32x32x16_bf16 v[112:127], v[16:19], v[24:27], v[112:127]
    ds_read_b128 v[76:79], v5 offset:40960
    ds_read_b64_tr_b16 v[84:85], v8 offset:10240
    ds_read_b64_tr_b16 v[86:87], v8 offset:10752
    ds_read_b128 v[80:83], v5 offset:45056
    v_mfma_f32_32x32x16_bf16 v[128:143], v[20:23], v[24:27], v[128:143]
    ds_read_b128 v[88:91], v6 offset:40960
    ds_read_b64_tr_b16 v[96:97], v8 offset:12288
    ds_read_b64_tr_b16 v[98:99], v8 offset:12800
    ds_read_b128 v[92:95], v6 offset:45056
    v_mfma_f32_32x32x16_bf16 v[112:127], v[28:31], v[36:39], v[112:127]
    ds_read_b128 v[100:103], v7 offset:40960
    ds_read_b64_tr_b16 v[108:109], v8 offset:14336
    ds_read_b64_tr_b16 v[110:111], v8 offset:14848
    ds_read_b128 v[104:107], v7 offset:45056
    v_mfma_f32_32x32x16_bf16 v[128:143], v[32:35], v[36:39], v[128:143]
    s_add_u32 s49, s46, 5
    s_and_b32 s49, s49, 7
    s_lshl_b32 s49, s49, 7
    v_add_u32 v0, s49, v11
    s_mov_b64 exec, s[100:101]
    ds_read_b128 v[176:179], v0
    ds_read_b128 v[180:183], v0 offset:32
    s_mov_b64 exec, -1
    v_mfma_f32_32x32x16_bf16 v[112:127], v[40:43], v[48:51], v[112:127]
    v_mfma_f32_32x32x16_bf16 v[128:143], v[44:47], v[48:51], v[128:143]
    v_mfma_f32_32x32x16_bf16 v[112:127], v[52:55], v[60:63], v[112:127]
    s_waitcnt lgkmcnt(0)
    s_barrier
    v_mfma_f32_32x32x16_bf16 v[128:143], v[56:59], v[60:63], v[128:143]
    v_mfma_f32_16x16x32_bf16 v[184:187], v[176:179], v[88:91], v[184:187]
    v_mfma_f32_16x16x32_bf16 v[188:191], v[176:179], v[92:95], v[188:191]
    v_mfma_f32_16x16x32_bf16 v[184:187], v[180:183], v[100:103], v[184:187]
    v_mfma_f32_16x16x32_bf16 v[188:191], v[180:183], v[104:107], v[188:191]
    ds_read_b128 v[16:19], v4 offset:49152
    ds_read_b64_tr_b16 v[24:25], v8 offset:24576
    ds_read_b64_tr_b16 v[26:27], v8 offset:25088
    ds_read_b128 v[20:23], v4 offset:53248
    v_mfma_f32_32x32x16_bf16 v[112:127], v[64:67], v[72:75], v[112:127]
    ds_read_b128 v[28:31], v5 offset:49152
    ds_read_b64_tr_b16 v[36:37], v8 offset:26624
    ds_read_b64_tr_b16 v[38:39], v8 offset:27136
    ds_read_b128 v[32:35], v5 offset:53248
    v_mfma_f32_32x32x16_bf16 v[128:143], v[68:71], v[72:75], v[128:143]
    ds_read_b128 v[40:43], v6 offset:49152
    ds_read_b64_tr_b16 v[48:49], v8 offset:28672
    ds_read_b64_tr_b16 v[50:51], v8 offset:29184
    ds_read_b128 v[44:47], v6 offset:53248
    v_mfma_f32_32x32x16_bf16 v[112:127], v[76:79], v[84:87], v[112:127]
    ds_read_b128 v[52:55], v7 offset:49152
    ds_read_b64_tr_b16 v[60:61], v8 offset:30720
    ds_read_b64_tr_b16 v[62:63], v8 offset:31232
    ds_read_b128 v[56:59], v7 offset:53248
    v_mfma_f32_32x32x16_bf16 v[128:143], v[80:83], v[84:87], v[128:143]
    s_add_u32 s49, s46, 6
    s_and_b32 s49, s49, 7
    s_lshl_b32 s49, s49, 7
    v_add_u32 v0, s49, v11
    s_mov_b64 exec, s[100:101]
    ds_read_b128 v[176:179], v0
    ds_read_b128 v[180:183], v0 offset:32
    s_mov_b64 exec, -1
    v_mfma_f32_32x32x16_bf16 v[112:127], v[88:91], v[96:99], v[112:127]
    v_mfma_f32_32x32x16_bf16 v[128:143], v[92:95], v[96:99], v[128:143]
    v_mfma_f32_32x32x16_bf16 v[112:127], v[100:103], v[108:111], v[112:127]
    s_waitcnt lgkmcnt(0)
    s_barrier
    v_mfma_f32_32x32x16_bf16 v[128:143], v[104:107], v[108:111], v[128:143]
    v_mfma_f32_16x16x32_bf16 v[184:187], v[176:179], v[40:43], v[184:187]
    v_mfma_f32_16x16x32_bf16 v[188:191], v[176:179], v[44:47], v[188:191]
    v_mfma_f32_16x16x32_bf16 v[184:187], v[180:183], v[52:55], v[184:187]
    v_mfma_f32_16x16x32_bf16 v[188:191], v[180:183], v[56:59], v[188:191]
    ds_read_b128 v[64:67], v4 offset:57344
    ds_read_b64_tr_b16 v[72:73], v8 offset:40960
    ds_read_b64_tr_b16 v[74:75], v8 offset:41472
    ds_read_b128 v[68:71], v4 offset:61440
    v_mfma_f32_32x32x16_bf16 v[112:127], v[16:19], v[24:27], v[112:127]
    ds_read_b128 v[76:79], v5 offset:57344
    ds_read_b64_tr_b16 v[84:85], v8 offset:43008
    ds_read_b64_tr_b16 v[86:87], v8 offset:43520
    ds_read_b128 v[80:83], v5 offset:61440
    v_mfma_f32_32x32x16_bf16 v[128:143], v[20:23], v[24:27], v[128:143]
    ds_read_b128 v[88:91], v6 offset:57344
    ds_read_b64_tr_b16 v[96:97], v8 offset:45056
    ds_read_b64_tr_b16 v[98:99], v8 offset:45568
    ds_read_b128 v[92:95], v6 offset:61440
    v_mfma_f32_32x32x16_bf16 v[112:127], v[28:31], v[36:39], v[112:127]
    ds_read_b128 v[100:103], v7 offset:57344
    ds_read_b64_tr_b16 v[108:109], v8 offset:47104
    ds_read_b64_tr_b16 v[110:111], v8 offset:47616
    ds_read_b128 v[104:107], v7 offset:61440
    v_mfma_f32_32x32x16_bf16 v[128:143], v[32:35], v[36:39], v[128:143]
    s_add_u32 s49, s46, 7
    s_and_b32 s49, s49, 7
    s_lshl_b32 s49, s49, 7
    v_add_u32 v0, s49, v11
    s_mov_b64 exec, s[100:101]
    ds_read_b128 v[176:179], v0
    ds_read_b128 v[180:183], v0 offset:32
    s_mov_b64 exec, -1
    v_mfma_f32_32x32x16_bf16 v[112:127], v[40:43], v[48:51], v[112:127]
    v_mfma_f32_32x32x16_bf16 v[128:143], v[44:47], v[48:51], v[128:143]
    v_mfma_f32_32x32x16_bf16 v[112:127], v[52:55], v[60:63], v[112:127]
    s_waitcnt lgkmcnt(0)
    s_barrier
    v_mfma_f32_32x32x16_bf16 v[128:143], v[56:59], v[60:63], v[128:143]
    v_mfma_f32_16x16x32_bf16 v[184:187], v[176:179], v[88:91], v[184:187]
    v_mfma_f32_16x16x32_bf16 v[188:191], v[176:179], v[92:95], v[188:191]
    v_mfma_f32_16x16x32_bf16 v[184:187], v[180:183], v[100:103], v[184:187]
    v_mfma_f32_16x16x32_bf16 v[188:191], v[180:183], v[104:107], v[188:191]
    ds_read_b128 v[16:19], v4 offset:0
    ds_read_b64_tr_b16 v[24:25], v8 offset:57344
    ds_read_b64_tr_b16 v[26:27], v8 offset:57856
    v_mfma_f32_32x32x16_bf16 v[112:127], v[64:67], v[72:75], v[112:127]
    ds_read_b128 v[20:23], v4 offset:4096
    ds_read_b64_tr_b16 v[28:29], v8 offset:61440
    ds_read_b64_tr_b16 v[30:31], v8 offset:61952
    v_mfma_f32_32x32x16_bf16 v[128:143], v[68:71], v[72:75], v[128:143]
    ds_read_b128 v[32:35], v5 offset:0
    ds_read_b64_tr_b16 v[40:41], v8 offset:59392
    ds_read_b64_tr_b16 v[42:43], v8 offset:59904
    v_mfma_f32_32x32x16_bf16 v[112:127], v[76:79], v[84:87], v[112:127]
    ds_read_b128 v[36:39], v5 offset:4096
    ds_read_b64_tr_b16 v[44:45], v8 offset:63488
    ds_read_b64_tr_b16 v[46:47], v8 offset:64000
    v_mfma_f32_32x32x16_bf16 v[128:143], v[80:83], v[84:87], v[128:143]
    v_mfma_f32_32x32x16_bf16 v[112:127], v[88:91], v[96:99], v[112:127]
    v_mfma_f32_32x32x16_bf16 v[128:143], v[92:95], v[96:99], v[128:143]
    v_mfma_f32_32x32x16_bf16 v[112:127], v[100:103], v[108:111], v[112:127]
    buffer_load_dword v12, v13, s[36:39], 0 offen sc1
    s_waitcnt lgkmcnt(0)
    s_barrier
    v_mfma_f32_32x32x16_bf16 v[128:143], v[104:107], v[108:111], v[128:143]
    v_mov_b32 v0, v184
    v_mov_b32 v11, v185
    v_mov_b32 v2, v188
    v_mov_b32 v3, v189
    ds_read_b128 v[64:67], v6 offset:0
    ds_read_b64_tr_b16 v[72:73], v9 offset:8192
    ds_read_b64_tr_b16 v[74:75], v9 offset:8704
    v_mfma_f32_32x32x16_bf16 v[48:63], v[24:27], v[16:19], 0
    ds_read_b128 v[68:71], v6 offset:4096
    ds_read_b64_tr_b16 v[76:77], v9 offset:12288
    ds_read_b64_tr_b16 v[78:79], v9 offset:12800
    v_mfma_f32_32x32x16_bf16 v[96:111], v[24:27], v[20:23], 0
    ds_read_b128 v[80:83], v7 offset:0
    ds_read_b64_tr_b16 v[88:89], v9 offset:10240
    ds_read_b64_tr_b16 v[90:91], v9 offset:10752
    v_mfma_f32_32x32x16_bf16 v[144:159], v[28:31], v[16:19], v[144:159]
    ds_read_b128 v[84:87], v7 offset:4096
    ds_read_b64_tr_b16 v[92:93], v9 offset:14336
    ds_read_b64_tr_b16 v[94:95], v9 offset:14848
    v_mfma_f32_32x32x16_bf16 v[160:175], v[28:31], v[20:23], v[160:175]
    s_add_u32 s49, s44, 2
    s_and_b32 s49, s49, 7
    s_lshl_b32 s49, s49, 2
    s_and_b32 s50, s47, 1
    s_lshl_b32 s50, s50, 1
    s_add_u32 s49, s49, s50
    s_mul_i32 s49, s49, 131072
    s_lshl_b32 s50, s45, 12
    v_mfma_f32_32x32x16_bf16 v[48:63], v[40:43], v[32:35], v[48:63]
    s_add_u32 s49, s49, s50
    s_add_u32 s50, s49, 131072
    s_mov_b32 s53, s49
    s_mov_b32 s54, s50
    v_cvt_pk_bf16_f32 v176, v112, v113
    v_cvt_pk_bf16_f32 v177, v114, v115
    v_cvt_pk_bf16_f32 v178, v116, v117
    v_cvt_pk_bf16_f32 v179, v118, v119
    v_mfma_f32_32x32x16_bf16 v[96:111], v[40:43], v[36:39], v[96:111]
    buffer_store_dwordx4 v[176:179], v10, s[16:19], s53 offen offset:0 sc1
    v_cvt_pk_bf16_f32 v180, v120, v121
    v_cvt_pk_bf16_f32 v181, v122, v123
    v_cvt_pk_bf16_f32 v182, v124, v125
    v_cvt_pk_bf16_f32 v183, v126, v127
    buffer_store_dwordx4 v[180:183], v10, s[16:19], s53 offen offset:512 sc1
    v_cvt_pk_bf16_f32 v184, v128, v129
    v_cvt_pk_bf16_f32 v185, v130, v131
    v_mfma_f32_32x32x16_bf16 v[144:159], v[44:47], v[32:35], v[144:159]
    v_cvt_pk_bf16_f32 v186, v132, v133
    v_cvt_pk_bf16_f32 v187, v134, v135
    buffer_store_dwordx4 v[184:187], v10, s[16:19], s53 offen offset:2048 sc1
    v_cvt_pk_bf16_f32 v188, v136, v137
    v_cvt_pk_bf16_f32 v189, v138, v139
    v_cvt_pk_bf16_f32 v190, v140, v141
    v_cvt_pk_bf16_f32 v191, v142, v143
    buffer_store_dwordx4 v[188:191], v10, s[16:19], s53 offen offset:2560 sc1
    s_waitcnt lgkmcnt(0)
    s_barrier
    v_mfma_f32_32x32x16_bf16 v[160:175], v[44:47], v[36:39], v[160:175]
    ds_read_b128 v[16:19], v4 offset:8192
    ds_read_b64_tr_b16 v[24:25], v8 offset:8192
    ds_read_b64_tr_b16 v[26:27], v8 offset:8704
    v_mfma_f32_32x32x16_bf16 v[48:63], v[72:75], v[64:67], v[48:63]
    ds_read_b128 v[20:23], v4 offset:12288
    ds_read_b64_tr_b16 v[28:29], v8 offset:12288
    ds_read_b64_tr_b16 v[30:31], v8 offset:12800
    v_mfma_f32_32x32x16_bf16 v[96:111], v[72:75], v[68:71], v[96:111]
    ds_read_b128 v[32:35], v5 offset:8192
    ds_read_b64_tr_b16 v[40:41], v8 offset:10240
    ds_read_b64_tr_b16 v[42:43], v8 offset:10752
    v_mfma_f32_32x32x16_bf16 v[144:159], v[76:79], v[64:67], v[144:159]
    ds_read_b128 v[36:39], v5 offset:12288
    ds_read_b64_tr_b16 v[44:45], v8 offset:14336
    ds_read_b64_tr_b16 v[46:47], v8 offset:14848
    v_mfma_f32_32x32x16_bf16 v[160:175], v[76:79], v[68:71], v[160:175]
    v_mfma_f32_32x32x16_bf16 v[48:63], v[88:91], v[80:83], v[48:63]
    v_mfma_f32_32x32x16_bf16 v[96:111], v[88:91], v[84:87], v[96:111]
    v_mfma_f32_32x32x16_bf16 v[144:159], v[92:95], v[80:83], v[144:159]
    s_waitcnt lgkmcnt(0)
    s_barrier
    v_mfma_f32_32x32x16_bf16 v[160:175], v[92:95], v[84:87], v[160:175]
    ds_read_b128 v[64:67], v6 offset:8192
    ds_read_b64_tr_b16 v[72:73], v8 offset:24576
    ds_read_b64_tr_b16 v[74:75], v8 offset:25088
    v_mfma_f32_32x32x16_bf16 v[48:63], v[24:27], v[16:19], v[48:63]
    ds_read_b128 v[68:71], v6 offset:12288
    ds_read_b64_tr_b16 v[76:77], v8 offset:28672
    ds_read_b64_tr_b16 v[78:79], v8 offset:29184
    v_mfma_f32_32x32x16_bf16 v[96:111], v[24:27], v[20:23], v[96:111]
    ds_read_b128 v[80:83], v7 offset:8192
    ds_read_b64_tr_b16 v[88:89], v8 offset:26624
    ds_read_b64_tr_b16 v[90:91], v8 offset:27136
    v_mfma_f32_32x32x16_bf16 v[144:159], v[28:31], v[16:19], v[144:159]
    ds_read_b128 v[84:87], v7 offset:12288
    ds_read_b64_tr_b16 v[92:93], v8 offset:30720
    ds_read_b64_tr_b16 v[94:95], v8 offset:31232
    v_mfma_f32_32x32x16_bf16 v[160:175], v[28:31], v[20:23], v[160:175]
    v_mfma_f32_32x32x16_bf16 v[48:63], v[40:43], v[32:35], v[48:63]
    v_mfma_f32_32x32x16_bf16 v[96:111], v[40:43], v[36:39], v[96:111]
    v_mfma_f32_32x32x16_bf16 v[144:159], v[44:47], v[32:35], v[144:159]
    s_waitcnt lgkmcnt(0)
    s_barrier
    v_mfma_f32_32x32x16_bf16 v[160:175], v[44:47], v[36:39], v[160:175]
    ds_read_b128 v[16:19], v4 offset:16384
    ds_read_b64_tr_b16 v[24:25], v8 offset:40960
    ds_read_b64_tr_b16 v[26:27], v8 offset:41472
    v_mfma_f32_32x32x16_bf16 v[48:63], v[72:75], v[64:67], v[48:63]
    ds_read_b128 v[20:23], v4 offset:20480
    ds_read_b64_tr_b16 v[28:29], v8 offset:45056
    ds_read_b64_tr_b16 v[30:31], v8 offset:45568
    v_mfma_f32_32x32x16_bf16 v[96:111], v[72:75], v[68:71], v[96:111]
    ds_read_b128 v[32:35], v5 offset:16384
    ds_read_b64_tr_b16 v[40:41], v8 offset:43008
    ds_read_b64_tr_b16 v[42:43], v8 offset:43520
    v_mfma_f32_32x32x16_bf16 v[144:159], v[76:79], v[64:67], v[144:159]
    ds_read_b128 v[36:39], v5 offset:20480
    ds_read_b64_tr_b16 v[44:45], v8 offset:47104
    ds_read_b64_tr_b16 v[46:47], v8 offset:47616
    v_mfma_f32_32x32x16_bf16 v[160:175], v[76:79], v[68:71], v[160:175]
    v_mfma_f32_32x32x16_bf16 v[48:63], v[88:91], v[80:83], v[48:63]
    v_mfma_f32_32x32x16_bf16 v[96:111], v[88:91], v[84:87], v[96:111]
    v_mfma_f32_32x32x16_bf16 v[144:159], v[92:95], v[80:83], v[144:159]
    s_waitcnt lgkmcnt(0)
    s_barrier
    v_mfma_f32_32x32x16_bf16 v[160:175], v[92:95], v[84:87], v[160:175]
    ds_read_b128 v[64:67], v6 offset:16384
    ds_read_b64_tr_b16 v[72:73], v8 offset:57344
    ds_read_b64_tr_b16 v[74:75], v8 offset:57856
    v_mfma_f32_32x32x16_bf16 v[48:63], v[24:27], v[16:19], v[48:63]
    ds_read_b128 v[68:71], v6 offset:20480
    ds_read_b64_tr_b16 v[76:77], v8 offset:61440
    ds_read_b64_tr_b16 v[78:79], v8 offset:61952
    v_mfma_f32_32x32x16_bf16 v[96:111], v[24:27], v[20:23], v[96:111]
    ds_read_b128 v[80:83], v7 offset:16384
    ds_read_b64_tr_b16 v[88:89], v8 offset:59392
    ds_read_b64_tr_b16 v[90:91], v8 offset:59904
    v_mfma_f32_32x32x16_bf16 v[144:159], v[28:31], v[16:19], v[144:159]
    ds_read_b128 v[84:87], v7 offset:20480
    ds_read_b64_tr_b16 v[92:93], v8 offset:63488
    ds_read_b64_tr_b16 v[94:95], v8 offset:64000
    v_mfma_f32_32x32x16_bf16 v[160:175], v[28:31], v[20:23], v[160:175]
    v_mfma_f32_32x32x16_bf16 v[48:63], v[40:43], v[32:35], v[48:63]
    v_mfma_f32_32x32x16_bf16 v[96:111], v[40:43], v[36:39], v[96:111]
    v_mfma_f32_32x32x16_bf16 v[144:159], v[44:47], v[32:35], v[144:159]
    s_waitcnt lgkmcnt(0)
    s_waitcnt vmcnt(0)
    s_mov_b32 s65, 100000
L_np_16:
    v_readfirstlane_b32 s48, v12
    s_sub_u32 s65, s65, 1
    s_cbranch_scc1 L_nn_15
    s_cmp_lg_u32 s48, 0
    s_cbranch_scc1 L_nn_15
    buffer_load_dword v12, v13, s[36:39], 0 offen sc1
    s_waitcnt vmcnt(0)
    s_branch L_np_16
L_nn_15:
    s_barrier
    v_mfma_f32_32x32x16_bf16 v[160:175], v[44:47], v[36:39], v[160:175]
    ds_read_b128 v[16:19], v4 offset:24576
    ds_read_b64_tr_b16 v[24:25], v9 offset:8192
    ds_read_b64_tr_b16 v[26:27], v9 offset:8704
    v_mfma_f32_32x32x16_bf16 v[48:63], v[72:75], v[64:67], v[48:63]
    ds_read_b128 v[20:23], v4 offset:28672
    ds_read_b64_tr_b16 v[28:29], v9 offset:12288
    ds_read_b64_tr_b16 v[30:31], v9 offset:12800
    v_mfma_f32_32x32x16_bf16 v[96:111], v[72:75], v[68:71], v[96:111]
    ds_read_b128 v[32:35], v5 offset:24576
    ds_read_b64_tr_b16 v[40:41], v9 offset:10240
    ds_read_b64_tr_b16 v[42:43], v9 offset:10752
    v_mfma_f32_32x32x16_bf16 v[144:159], v[76:79], v[64:67], v[144:159]
    ds_read_b128 v[36:39], v5 offset:28672
    ds_read_b64_tr_b16 v[44:45], v9 offset:14336
    ds_read_b64_tr_b16 v[46:47], v9 offset:14848
    v_mfma_f32_32x32x16_bf16 v[160:175], v[76:79], v[68:71], v[160:175]
    v_mfma_f32_32x32x16_bf16 v[48:63], v[88:91], v[80:83], v[48:63]
    v_mfma_f32_32x32x16_bf16 v[96:111], v[88:91], v[84:87], v[96:111]
    v_mfma_f32_32x32x16_bf16 v[144:159], v[92:95], v[80:83], v[144:159]
    s_waitcnt lgkmcnt(0)
    s_barrier
    v_mfma_f32_32x32x16_bf16 v[160:175], v[92:95], v[84:87], v[160:175]
    ds_read_b128 v[64:67], v6 offset:24576
    ds_read_b64_tr_b16 v[72:73], v8 offset:8192
    ds_read_b64_tr_b16 v[74:75], v8 offset:8704
    v_mfma_f32_32x32x16_bf16 v[48:63], v[24:27], v[16:19], v[48:63]
    ds_read_b128 v[68:71], v6 offset:28672
    ds_read_b64_tr_b16 v[76:77], v8 offset:12288
    ds_read_b64_tr_b16 v[78:79], v8 offset:12800
    v_mfma_f32_32x32x16_bf16 v[96:111], v[24:27], v[20:23], v[96:111]
    ds_read_b128 v[80:83], v7 offset:24576
    ds_read_b64_tr_b16 v[88:89], v8 offset:10240
    ds_read_b64_tr_b16 v[90:91], v8 offset:10752
    v_mfma_f32_32x32x16_bf16 v[144:159], v[28:31], v[16:19], v[144:159]
    ds_read_b128 v[84:87], v7 offset:28672
    ds_read_b64_tr_b16 v[92:93], v8 offset:14336
    ds_read_b64_tr_b16 v[94:95], v8 offset:14848
    v_mfma_f32_32x32x16_bf16 v[160:175], v[28:31], v[20:23], v[160:175]
    v_mfma_f32_32x32x16_bf16 v[48:63], v[40:43], v[32:35], v[48:63]
    v_mfma_f32_32x32x16_bf16 v[96:111], v[40:43], v[36:39], v[96:111]
    v_mfma_f32_32x32x16_bf16 v[144:159], v[44:47], v[32:35], v[144:159]
    s_waitcnt lgkmcnt(0)
    s_barrier
    v_mfma_f32_32x32x16_bf16 v[160:175], v[44:47], v[36:39], v[160:175]
    ds_read_b128 v[16:19], v4 offset:32768
    ds_read_b64_tr_b16 v[24:25], v8 offset:24576
    ds_read_b64_tr_b16 v[26:27], v8 offset:25088
    v_mfma_f32_32x32x16_bf16 v[48:63], v[72:75], v[64:67], v[48:63]
    ds_read_b128 v[20:23], v4 offset:36864
    ds_read_b64_tr_b16 v[28:29], v8 offset:28672
    ds_read_b64_tr_b16 v[30:31], v8 offset:29184
    v_mfma_f32_32x32x16_bf16 v[96:111], v[72:75], v[68:71], v[96:111]
    ds_read_b128 v[32:35], v5 offset:32768
    ds_read_b64_tr_b16 v[40:41], v8 offset:26624
    ds_read_b64_tr_b16 v[42:43], v8 offset:27136
    v_mfma_f32_32x32x16_bf16 v[144:159], v[76:79], v[64:67], v[144:159]
    ds_read_b128 v[36:39], v5 offset:36864
    ds_read_b64_tr_b16 v[44:45], v8 offset:30720
    ds_read_b64_tr_b16 v[46:47], v8 offset:31232
    v_mfma_f32_32x32x16_bf16 v[160:175], v[76:79], v[68:71], v[160:175]
    v_mfma_f32_32x32x16_bf16 v[48:63], v[88:91], v[80:83], v[48:63]
    v_mfma_f32_32x32x16_bf16 v[96:111], v[88:91], v[84:87], v[96:111]
    v_mfma_f32_32x32x16_bf16 v[144:159], v[92:95], v[80:83], v[144:159]
    s_waitcnt lgkmcnt(0)
    s_barrier
    v_mfma_f32_32x32x16_bf16 v[160:175], v[92:95], v[84:87], v[160:175]
    ds_read_b128 v[64:67], v6 offset:32768
    ds_read_b64_tr_b16 v[72:73], v8 offset:40960
    ds_read_b64_tr_b16 v[74:75], v8 offset:41472
    v_mfma_f32_32x32x16_bf16 v[48:63], v[24:27], v[16:19], v[48:63]
    ds_read_b128 v[68:71], v6 offset:36864
    ds_read_b64_tr_b16 v[76:77], v8 offset:45056
    ds_read_b64_tr_b16 v[78:79], v8 offset:45568
    v_mfma_f32_32x32x16_bf16 v[96:111], v[24:27], v[20:23], v[96:111]
    ds_read_b128 v[80:83], v7 offset:32768
    ds_read_b64_tr_b16 v[88:89], v8 offset:43008
    ds_read_b64_tr_b16 v[90:91], v8 offset:43520
    v_mfma_f32_32x32x16_bf16 v[144:159], v[28:31], v[16:19], v[144:159]
    ds_read_b128 v[84:87], v7 offset:36864
    ds_read_b64_tr_b16 v[92:93], v8 offset:47104
    ds_read_b64_tr_b16 v[94:95], v8 offset:47616
    v_mfma_f32_32x32x16_bf16 v[160:175], v[28:31], v[20:23], v[160:175]
    v_mfma_f32_32x32x16_bf16 v[48:63], v[40:43], v[32:35], v[48:63]
    v_mfma_f32_32x32x16_bf16 v[96:111], v[40:43], v[36:39], v[96:111]
    v_mfma_f32_32x32x16_bf16 v[144:159], v[44:47], v[32:35], v[144:159]
    s_waitcnt lgkmcnt(0)
    s_barrier
    v_mfma_f32_32x32x16_bf16 v[160:175], v[44:47], v[36:39], v[160:175]
    ds_read_b128 v[16:19], v4 offset:40960
    ds_read_b64_tr_b16 v[24:25], v8 offset:57344
    ds_read_b64_tr_b16 v[26:27], v8 offset:57856
    v_mfma_f32_32x32x16_bf16 v[48:63], v[72:75], v[64:67], v[48:63]
    ds_read_b128 v[20:23], v4 offset:45056
    ds_read_b64_tr_b16 v[28:29], v8 offset:61440
    ds_read_b64_tr_b16 v[30:31], v8 offset:61952
    v_mfma_f32_32x32x16_bf16 v[96:111], v[72:75], v[68:71], v[96:111]
    ds_read_b128 v[32:35], v5 offset:40960
    ds_read_b64_tr_b16 v[40:41], v8 offset:59392
    ds_read_b64_tr_b16 v[42:43], v8 offset:59904
    v_mfma_f32_32x32x16_bf16 v[144:159], v[76:79], v[64:67], v[144:159]
    ds_read_b128 v[36:39], v5 offset:45056
    ds_read_b64_tr_b16 v[44:45], v8 offset:63488
    ds_read_b64_tr_b16 v[46:47], v8 offset:64000
    v_mfma_f32_32x32x16_bf16 v[160:175], v[76:79], v[68:71], v[160:175]
    v_mfma_f32_32x32x16_bf16 v[48:63], v[88:91], v[80:83], v[48:63]
    v_mfma_f32_32x32x16_bf16 v[96:111], v[88:91], v[84:87], v[96:111]
    v_mfma_f32_32x32x16_bf16 v[144:159], v[92:95], v[80:83], v[144:159]
    s_waitcnt lgkmcnt(0)
    s_barrier
    v_mfma_f32_32x32x16_bf16 v[160:175], v[92:95], v[84:87], v[160:175]
    ds_read_b128 v[64:67], v6 offset:40960
    ds_read_b64_tr_b16 v[72:73], v9 offset:8192
    ds_read_b64_tr_b16 v[74:75], v9 offset:8704
    v_mfma_f32_32x32x16_bf16 v[48:63], v[24:27], v[16:19], v[48:63]
    ds_read_b128 v[68:71], v6 offset:45056
    ds_read_b64_tr_b16 v[76:77], v9 offset:12288
    ds_read_b64_tr_b16 v[78:79], v9 offset:12800
    v_mfma_f32_32x32x16_bf16 v[96:111], v[24:27], v[20:23], v[96:111]
    ds_read_b128 v[80:83], v7 offset:40960
    ds_read_b64_tr_b16 v[88:89], v9 offset:10240
    ds_read_b64_tr_b16 v[90:91], v9 offset:10752
    v_mfma_f32_32x32x16_bf16 v[144:159], v[28:31], v[16:19], v[144:159]
    ds_read_b128 v[84:87], v7 offset:45056
    ds_read_b64_tr_b16 v[92:93], v9 offset:14336
    ds_read_b64_tr_b16 v[94:95], v9 offset:14848
    v_mfma_f32_32x32x16_bf16 v[160:175], v[28:31], v[20:23], v[160:175]
    v_mfma_f32_32x32x16_bf16 v[48:63], v[40:43], v[32:35], v[48:63]
    v_mfma_f32_32x32x16_bf16 v[96:111], v[40:43], v[36:39], v[96:111]
    v_mfma_f32_32x32x16_bf16 v[144:159], v[44:47], v[32:35], v[144:159]
    s_waitcnt lgkmcnt(0)
    s_barrier
    v_mfma_f32_32x32x16_bf16 v[160:175], v[44:47], v[36:39], v[160:175]
    ds_read_b128 v[16:19], v4 offset:49152
    ds_read_b64_tr_b16 v[24:25], v8 offset:8192
    ds_read_b64_tr_b16 v[26:27], v8 offset:8704
    v_mfma_f32_32x32x16_bf16 v[48:63], v[72:75], v[64:67], v[48:63]
    ds_read_b128 v[20:23], v4 offset:53248
    ds_read_b64_tr_b16 v[28:29], v8 offset:12288
    ds_read_b64_tr_b16 v[30:31], v8 offset:12800
    v_mfma_f32_32x32x16_bf16 v[96:111], v[72:75], v[68:71], v[96:111]
    ds_read_b128 v[32:35], v5 offset:49152
    ds_read_b64_tr_b16 v[40:41], v8 offset:10240
    ds_read_b64_tr_b16 v[42:43], v8 offset:10752
    v_mfma_f32_32x32x16_bf16 v[144:159], v[76:79], v[64:67], v[144:159]
    ds_read_b128 v[36:39], v5 offset:53248
    ds_read_b64_tr_b16 v[44:45], v8 offset:14336
    ds_read_b64_tr_b16 v[46:47], v8 offset:14848
    v_mfma_f32_32x32x16_bf16 v[160:175], v[76:79], v[68:71], v[160:175]
    v_mfma_f32_32x32x16_bf16 v[48:63], v[88:91], v[80:83], v[48:63]
    v_mfma_f32_32x32x16_bf16 v[96:111], v[88:91], v[84:87], v[96:111]
    v_mfma_f32_32x32x16_bf16 v[144:159], v[92:95], v[80:83], v[144:159]
    s_waitcnt lgkmcnt(0)
    s_barrier
    v_mfma_f32_32x32x16_bf16 v[160:175], v[92:95], v[84:87], v[160:175]
    ds_read_b128 v[64:67], v6 offset:49152
    ds_read_b64_tr_b16 v[72:73], v8 offset:24576
    ds_read_b64_tr_b16 v[74:75], v8 offset:25088
    v_mfma_f32_32x32x16_bf16 v[48:63], v[24:27], v[16:19], v[48:63]
    ds_read_b128 v[68:71], v6 offset:53248
    ds_read_b64_tr_b16 v[76:77], v8 offset:28672
    ds_read_b64_tr_b16 v[78:79], v8 offset:29184
    v_mfma_f32_32x32x16_bf16 v[96:111], v[24:27], v[20:23], v[96:111]
    ds_read_b128 v[80:83], v7 offset:49152
    ds_read_b64_tr_b16 v[88:89], v8 offset:26624
    ds_read_b64_tr_b16 v[90:91], v8 offset:27136
    v_mfma_f32_32x32x16_bf16 v[144:159], v[28:31], v[16:19], v[144:159]
    ds_read_b128 v[84:87], v7 offset:53248
    ds_read_b64_tr_b16 v[92:93], v8 offset:30720
    ds_read_b64_tr_b16 v[94:95], v8 offset:31232
    v_mfma_f32_32x32x16_bf16 v[160:175], v[28:31], v[20:23], v[160:175]
    v_mfma_f32_32x32x16_bf16 v[48:63], v[40:43], v[32:35], v[48:63]
    v_mfma_f32_32x32x16_bf16 v[96:111], v[40:43], v[36:39], v[96:111]
    v_mfma_f32_32x32x16_bf16 v[144:159], v[44:47], v[32:35], v[144:159]
    s_waitcnt lgkmcnt(0)
    s_barrier
    v_mfma_f32_32x32x16_bf16 v[160:175], v[44:47], v[36:39], v[160:175]
    ds_read_b128 v[16:19], v4 offset:57344
    ds_read_b64_tr_b16 v[24:25], v8 offset:40960
    ds_read_b64_tr_b16 v[26:27], v8 offset:41472
    v_mfma_f32_32x32x16_bf16 v[48:63], v[72:75], v[64:67], v[48:63]
    ds_read_b128 v[20:23], v4 offset:61440
    ds_read_b64_tr_b16 v[28:29], v8 offset:45056
    ds_read_b64_tr_b16 v[30:31], v8 offset:45568
    v_mfma_f32_32x32x16_bf16 v[96:111], v[72:75], v[68:71], v[96:111]
    ds_read_b128 v[32:35], v5 offset:57344
    ds_read_b64_tr_b16 v[40:41], v8 offset:43008
    ds_read_b64_tr_b16 v[42:43], v8 offset:43520
    v_mfma_f32_32x32x16_bf16 v[144:159], v[76:79], v[64:67], v[144:159]
    ds_read_b128 v[36:39], v5 offset:61440
    ds_read_b64_tr_b16 v[44:45], v8 offset:47104
    ds_read_b64_tr_b16 v[46:47], v8 offset:47616
    v_mfma_f32_32x32x16_bf16 v[160:175], v[76:79], v[68:71], v[160:175]
    v_mfma_f32_32x32x16_bf16 v[48:63], v[88:91], v[80:83], v[48:63]
    v_mfma_f32_32x32x16_bf16 v[96:111], v[88:91], v[84:87], v[96:111]
    v_mfma_f32_32x32x16_bf16 v[144:159], v[92:95], v[80:83], v[144:159]
    s_waitcnt lgkmcnt(0)
    s_barrier
    v_mfma_f32_32x32x16_bf16 v[160:175], v[92:95], v[84:87], v[160:175]
    ds_read_b128 v[64:67], v6 offset:57344
    ds_read_b64_tr_b16 v[72:73], v8 offset:57344
    ds_read_b64_tr_b16 v[74:75], v8 offset:57856
    v_mfma_f32_32x32x16_bf16 v[48:63], v[24:27], v[16:19], v[48:63]
    ds_read_b128 v[68:71], v6 offset:61440
    ds_read_b64_tr_b16 v[76:77], v8 offset:61440
    ds_read_b64_tr_b16 v[78:79], v8 offset:61952
    v_mfma_f32_32x32x16_bf16 v[96:111], v[24:27], v[20:23], v[96:111]
    ds_read_b128 v[80:83], v7 offset:57344
    ds_read_b64_tr_b16 v[88:89], v8 offset:59392
    ds_read_b64_tr_b16 v[90:91], v8 offset:59904
    v_mfma_f32_32x32x16_bf16 v[144:159], v[28:31], v[16:19], v[144:159]
    ds_read_b128 v[84:87], v7 offset:61440
    ds_read_b64_tr_b16 v[92:93], v8 offset:63488
    ds_read_b64_tr_b16 v[94:95], v8 offset:64000
    v_mfma_f32_32x32x16_bf16 v[160:175], v[28:31], v[20:23], v[160:175]
    v_mfma_f32_32x32x16_bf16 v[48:63], v[40:43], v[32:35], v[48:63]
    v_mfma_f32_32x32x16_bf16 v[96:111], v[40:43], v[36:39], v[96:111]
    v_mfma_f32_32x32x16_bf16 v[144:159], v[44:47], v[32:35], v[144:159]
    s_waitcnt lgkmcnt(0)
    v_mfma_f32_32x32x16_bf16 v[160:175], v[44:47], v[36:39], v[160:175]
    v_mfma_f32_32x32x16_bf16 v[48:63], v[72:75], v[64:67], v[48:63]
    v_mfma_f32_32x32x16_bf16 v[96:111], v[72:75], v[68:71], v[96:111]
    v_mfma_f32_32x32x16_bf16 v[48:63], v[88:91], v[80:83], v[48:63]
    s_barrier
    s_setprio 0
    v_mfma_f32_32x32x16_bf16 v[96:111], v[88:91], v[84:87], v[96:111]
    v_lshlrev_b32 v4, 2, v255
    v_add_u32 v4, 148736, v4
    s_mov_b64 exec, 0xffff
    ds_write_b32 v4, v0
    ds_write_b32 v4, v11 offset:64
    ds_write_b32 v4, v2 offset:128
    ds_write_b32 v4, v3 offset:192
    s_mov_b64 exec, -1
    v_mfma_f32_32x32x16_bf16 v[144:159], v[76:79], v[64:67], v[144:159]
    s_and_b32 s49, s47, 1
    s_lshl_b32 s49, s49, 12
    s_add_u32 s49, s49, 65536
    v_add_u32 v3, s49, v248
    s_nop 1
    v_cvt_pk_bf16_f32 v16, v48, v49
    v_cvt_pk_bf16_f32 v17, v50, v51
    v_cvt_pk_bf16_f32 v18, v52, v53
    v_cvt_pk_bf16_f32 v19, v54, v55
    ds_write_b128 v3, v[16:19] offset:0
    v_mfma_f32_32x32x16_bf16 v[160:175], v[76:79], v[68:71], v[160:175]
    v_cvt_pk_bf16_f32 v20, v56, v57
    v_cvt_pk_bf16_f32 v21, v58, v59
    v_cvt_pk_bf16_f32 v22, v60, v61
    v_cvt_pk_bf16_f32 v23, v62, v63
    ds_write_b128 v3, v[20:23] offset:2048
    v_mfma_f32_32x32x16_bf16 v[144:159], v[92:95], v[80:83], v[144:159]
    v_cvt_pk_bf16_f32 v24, v96, v97
    v_cvt_pk_bf16_f32 v25, v98, v99
    v_cvt_pk_bf16_f32 v26, v100, v101
    v_cvt_pk_bf16_f32 v27, v102, v103
    ds_write_b128 v3, v[24:27] offset:1024
    v_mfma_f32_32x32x16_bf16 v[160:175], v[92:95], v[84:87], v[160:175]
    v_cvt_pk_bf16_f32 v28, v104, v105
    v_cvt_pk_bf16_f32 v29, v106, v107
    v_cvt_pk_bf16_f32 v30, v108, v109
    v_cvt_pk_bf16_f32 v31, v110, v111
    ds_write_b128 v3, v[28:31] offset:3072
    v_mov_b32 v1, 149004
    v_mov_b32 v2, 1
    s_waitcnt lgkmcnt(0)
    s_mov_b64 exec, 1
    ds_add_u32 v1, v2
    s_mov_b64 exec, -1
    s_mov_b32 s59, s61
    s_add_u32 s60, s59, s58
    s_mov_b64 exec, s[62:63]
    buffer_load_dwordx4 v[192:195], v249, s[16:19], s60 offen sc1
    s_mov_b64 exec, -1
    buffer_load_dwordx4 v[112:115], v248, s[16:19], s60 offen sc1
    s_mov_b64 exec, s[62:63]
    buffer_load_dwordx4 v[216:219], v249, s[16:19], s60 offen offset:512 sc1
    s_add_u32 s59, s59, 2048
    s_and_b32 s59, s59, 0xffff
    s_add_u32 s60, s59, s58
    buffer_load_dwordx4 v[196:199], v249, s[16:19], s60 offen sc1
    s_mov_b64 exec, -1
    buffer_load_dwordx4 v[116:119], v248, s[16:19], s60 offen sc1
    v_pk_fma_f32 v[176:177], v[144:145], s[70:71], v[14:15]
    v_pk_fma_f32 v[178:179], v[146:147], s[70:71], v[14:15]
    v_pk_fma_f32 v[180:181], v[148:149], s[70:71], v[14:15]
    v_pk_fma_f32 v[182:183], v[150:151], s[70:71], v[14:15]
    v_exp_f32_e64 v176, v176 clamp
    v_exp_f32_e64 v177, v177 clamp
    v_exp_f32_e64 v178, v178 clamp
    v_exp_f32_e64 v179, v179 clamp
    v_exp_f32_e64 v180, v180 clamp
    v_exp_f32_e64 v181, v181 clamp
    v_exp_f32_e64 v182, v182 clamp
    v_exp_f32_e64 v183, v183 clamp
    v_max_f32 v144, s69, v144
    v_max_f32 v145, s69, v145
    v_max_f32 v146, s69, v146
    v_max_f32 v147, s69, v147
    v_max_f32 v148, s69, v148
    v_max_f32 v149, s69, v149
    v_max_f32 v150, s69, v150
    v_max_f32 v151, s69, v151
    v_pk_add_f32 v[144:145], v[176:177], v[144:145]
    v_pk_add_f32 v[146:147], v[178:179], v[146:147]
    v_pk_add_f32 v[148:149], v[180:181], v[148:149]
    v_pk_add_f32 v[150:151], v[182:183], v[150:151]
    v_pk_fma_f32 v[176:177], v[152:153], s[70:71], v[14:15]
    v_pk_fma_f32 v[178:179], v[154:155], s[70:71], v[14:15]
    v_pk_fma_f32 v[180:181], v[156:157], s[70:71], v[14:15]
    v_pk_fma_f32 v[182:183], v[158:159], s[70:71], v[14:15]
    v_exp_f32_e64 v176, v176 clamp
    v_exp_f32_e64 v177, v177 clamp
    v_exp_f32_e64 v178, v178 clamp
    v_exp_f32_e64 v179, v179 clamp
    v_exp_f32_e64 v180, v180 clamp
    v_exp_f32_e64 v181, v181 clamp
    v_exp_f32_e64 v182, v182 clamp
    v_exp_f32_e64 v183, v183 clamp
    v_max_f32 v152, s69, v152
    v_max_f32 v153, s69, v153
    v_max_f32 v154, s69, v154
    v_max_f32 v155, s69, v155
    v_max_f32 v156, s69, v156
    v_max_f32 v157, s69, v157
    v_max_f32 v158, s69, v158
    v_max_f32 v159, s69, v159
    v_pk_add_f32 v[152:153], v[176:177], v[152:153]
    v_pk_add_f32 v[154:155], v[178:179], v[154:155]
    v_pk_add_f32 v[156:157], v[180:181], v[156:157]
    v_pk_add_f32 v[158:159], v[182:183], v[158:159]
    v_cvt_pk_bf16_f32 v32, v144, v145
    v_cvt_pk_bf16_f32 v33, v146, v147
    v_cvt_pk_bf16_f32 v34, v148, v149
    v_cvt_pk_bf16_f32 v35, v150, v151
    ds_write_b128 v3, v[32:35] offset:8192
    v_cvt_pk_bf16_f32 v36, v152, v153
    v_cvt_pk_bf16_f32 v37, v154, v155
    v_cvt_pk_bf16_f32 v38, v156, v157
    v_cvt_pk_bf16_f32 v39, v158, v159
    ds_write_b128 v3, v[36:39] offset:10240
    v_pk_fma_f32 v[176:177], v[160:161], s[70:71], v[14:15]
    v_pk_fma_f32 v[178:179], v[162:163], s[70:71], v[14:15]
    v_pk_fma_f32 v[180:181], v[164:165], s[70:71], v[14:15]
    v_pk_fma_f32 v[182:183], v[166:167], s[70:71], v[14:15]
    v_exp_f32_e64 v176, v176 clamp
    v_exp_f32_e64 v177, v177 clamp
    v_exp_f32_e64 v178, v178 clamp
    v_exp_f32_e64 v179, v179 clamp
    v_exp_f32_e64 v180, v180 clamp
    v_exp_f32_e64 v181, v181 clamp
    v_exp_f32_e64 v182, v182 clamp
    v_exp_f32_e64 v183, v183 clamp
    v_max_f32 v160, s69, v160
    v_max_f32 v161, s69, v161
    v_max_f32 v162, s69, v162
    v_max_f32 v163, s69, v163
    v_max_f32 v164, s69, v164
    v_max_f32 v165, s69, v165
    v_max_f32 v166, s69, v166
    v_max_f32 v167, s69, v167
    v_pk_add_f32 v[160:161], v[176:177], v[160:161]
    v_pk_add_f32 v[162:163], v[178:179], v[162:163]
    v_pk_add_f32 v[164:165], v[180:181], v[164:165]
    v_pk_add_f32 v[166:167], v[182:183], v[166:167]
    v_pk_fma_f32 v[176:177], v[168:169], s[70:71], v[14:15]
    v_pk_fma_f32 v[178:179], v[170:171], s[70:71], v[14:15]
    v_pk_fma_f32 v[180:181], v[172:173], s[70:71], v[14:15]
    v_pk_fma_f32 v[182:183], v[174:175], s[70:71], v[14:15]
    v_exp_f32_e64 v176, v176 clamp
    v_exp_f32_e64 v177, v177 clamp
    v_exp_f32_e64 v178, v178 clamp
    v_exp_f32_e64 v179, v179 clamp
    v_exp_f32_e64 v180, v180 clamp
    v_exp_f32_e64 v181, v181 clamp
    v_exp_f32_e64 v182, v182 clamp
    v_exp_f32_e64 v183, v183 clamp
    v_max_f32 v168, s69, v168
    v_max_f32 v169, s69, v169
    v_max_f32 v170, s69, v170
    v_max_f32 v171, s69, v171
    v_max_f32 v172, s69, v172
    v_max_f32 v173, s69, v173
    v_max_f32 v174, s69, v174
    v_max_f32 v175, s69, v175
    v_pk_add_f32 v[168:169], v[176:177], v[168:169]
    v_pk_add_f32 v[170:171], v[178:179], v[170:171]
    v_pk_add_f32 v[172:173], v[180:181], v[172:173]
    v_pk_add_f32 v[174:175], v[182:183], v[174:175]
    v_cvt_pk_bf16_f32 v40, v160, v161
    v_cvt_pk_bf16_f32 v41, v162, v163
    v_cvt_pk_bf16_f32 v42, v164, v165
    v_cvt_pk_bf16_f32 v43, v166, v167
    ds_write_b128 v3, v[40:43] offset:9216
    v_cvt_pk_bf16_f32 v44, v168, v169
    v_cvt_pk_bf16_f32 v45, v170, v171
    v_cvt_pk_bf16_f32 v46, v172, v173
    v_cvt_pk_bf16_f32 v47, v174, v175
    ds_write_b128 v3, v[44:47] offset:11264
    v_mov_b32 v1, 149000
    v_mov_b32 v2, 1
    s_waitcnt lgkmcnt(0)
    s_mov_b64 exec, 1
    ds_add_u32 v1, v2
    s_mov_b64 exec, -1
    v_mov_b64 v[48:49], 0
    v_mov_b64 v[50:51], 0
    v_mov_b64 v[52:53], 0
    v_mov_b64 v[54:55], 0
    v_mov_b64 v[56:57], 0
    v_mov_b64 v[64:65], 0
    v_mov_b64 v[66:67], 0
    v_mov_b64 v[68:69], 0
    v_mov_b64 v[70:71], 0
    v_mov_b64 v[72:73], 0
L_attn:
    v_mov_b32 v3, 149004
    ds_read_b32 v244, v3
    s_mov_b64 exec, s[62:63]
    buffer_load_dwordx4 v[220:223], v249, s[16:19], s60 offen offset:512 sc1
    s_add_u32 s59, s59, 2048
    s_and_b32 s59, s59, 0xffff
    s_add_u32 s60, s59, s58
    buffer_load_dwordx4 v[200:203], v249, s[16:19], s60 offen sc1
    s_mov_b64 exec, -1
    buffer_load_dwordx4 v[120:123], v248, s[16:19], s60 offen sc1
    s_lshl_b32 s49, s66, 11
    s_lshl_b32 s50, s67, 10
    s_add_u32 s51, s49, s50
    s_add_u32 s51, s51, 65536
    s_xor_b32 s52, s51, 1024
    v_add_u32 v246, s51, v248
    v_add_u32 v2, s52, v248
    s_mov_b32 s65, 100000
L_q_17:
    s_waitcnt lgkmcnt(0)
    v_readfirstlane_b32 s49, v244
    s_sub_u32 s65, s65, 1
    s_cbranch_scc1 L_qok_18
    s_cmp_eq_u32 s49, 2
    s_cbranch_scc1 L_qok_18
    ds_read_b32 v244, v3
    s_branch L_q_17
L_qok_18:
    ds_read_b128 v[4:7], v2
    ds_read_b128 v[8:11], v246
    v_and_b32 v3, 31, v255
    v_lshlrev_b32 v254, 7, v3
    v_lshlrev_b32 v3, 2, v3
    s_lshl_b32 s49, s67, 7
    s_add_u32 s49, s49, 148480
    v_add_u32 v247, s49, v3
    s_lshl_b32 s49, s44, 1
    s_lshr_b32 s50, s66, 1
    s_add_u32 s49, s49, s50
    s_lshl_b32 s49, s49, 12
    s_add_u32 s49, s49, 9469952
    v_add_u32 v254, s49, v254
    v_mov_b32 v136, s48
    v_mov_b32 v137, 0
    s_waitcnt vmcnt(3) lgkmcnt(0)
    v_mfma_f32_32x32x16_bf16 v[16:31], v[112:115], v[4:7], 0
    v_lshrrev_b32 v1, 5, v255
    v_and_b32 v2, 15, v255
    v_lshlrev_b32 v2, 2, v2
    v_lshl_add_u32 v2, v1, 6, v2
    v_lshlrev_b32 v1, 4, v1
    v_add_u32 v1, 1024, v1
    v_cndmask_b32 v138, v2, v1, s[72:73]
    v_bfe_u32 v1, v255, 4, 1
    v_mul_u32_u24 v1, 2048, v1
    v_add_u32 v154, v1, v2
    v_and_b32 v153, 0xffffffbf, v154
    v_mov_b32 v245, 149000
    v_mov_b64 v[176:177], -1
    v_mov_b64 v[178:179], -1
    s_setprio 1
    v_exp_f32 v16, v16
    s_setprio 2
    v_exp_f32 v17, v17
    v_exp_f32 v18, v18
    v_exp_f32 v19, v19
    v_exp_f32 v20, v20
    v_mfma_f32_32x32x16_bf16 v[32:47], v[112:115], v[8:11], 0
    v_exp_f32 v21, v21
    v_exp_f32 v22, v22
    v_exp_f32 v23, v23
    v_exp_f32 v24, v24
    v_exp_f32 v25, v25
    v_smfmac_f32_32x32x32_bf16 v[48:63], v[192:195], v[16:23], v250
    v_exp_f32 v26, v26
    v_exp_f32 v27, v27
    v_exp_f32 v28, v28
    v_exp_f32 v29, v29
    v_exp_f32 v30, v30
    v_exp_f32 v31, v31
    v_exp_f32 v32, v32
    v_exp_f32 v33, v33
    v_smfmac_f32_32x32x32_bf16 v[48:63], v[216:219], v[24:31], v250
    v_exp_f32 v34, v34
    v_exp_f32 v35, v35
    v_exp_f32 v36, v36
    v_mfma_f32_32x32x16_bf16 v[16:31], v[116:119], v[4:7], 0
    v_exp_f32 v37, v37
    v_exp_f32 v38, v38
    v_exp_f32 v39, v39
    v_exp_f32 v40, v40
    v_exp_f32 v41, v41
    v_smfmac_f32_32x32x32_bf16 v[64:79], v[192:195], v[32:39], v250
    v_exp_f32 v42, v42
    v_exp_f32 v43, v43
    v_exp_f32 v44, v44
    v_exp_f32 v45, v45
    v_exp_f32 v46, v46
    v_exp_f32 v47, v47
    s_setprio 0
    s_mov_b64 exec, s[62:63]
    buffer_load_dwordx4 v[224:227], v249, s[16:19], s60 offen offset:512 sc1
    s_add_u32 s59, s59, 2048
    s_and_b32 s59, s59, 0xffff
    s_add_u32 s60, s59, s58
    buffer_load_dwordx4 v[204:207], v249, s[16:19], s60 offen sc1
    s_mov_b64 exec, -1
    buffer_load_dwordx4 v[124:127], v248, s[16:19], s60 offen sc1
    s_mov_b64 exec, s[62:63]
    buffer_load_dwordx4 v[228:231], v249, s[16:19], s60 offen offset:512 sc1
    s_add_u32 s59, s59, 2048
    s_and_b32 s59, s59, 0xffff
    s_add_u32 s60, s59, s58
    buffer_load_dwordx4 v[208:211], v249, s[16:19], s60 offen sc1
    s_mov_b64 exec, -1
    buffer_load_dwordx4 v[128:131], v248, s[16:19], s60 offen sc1
    s_waitcnt vmcnt(6)
    s_setprio 1
    v_exp_f32 v16, v16
    s_setprio 2
    v_exp_f32 v17, v17
    v_smfmac_f32_32x32x32_bf16 v[64:79], v[216:219], v[40:47], v250
    v_exp_f32 v18, v18
    v_exp_f32 v19, v19
    v_exp_f32 v20, v20
    v_mfma_f32_32x32x16_bf16 v[32:47], v[116:119], v[8:11], 0
    v_exp_f32 v21, v21
    v_exp_f32 v22, v22
    v_exp_f32 v23, v23
    v_exp_f32 v24, v24
    v_exp_f32 v25, v25
    v_smfmac_f32_32x32x32_bf16 v[48:63], v[196:199], v[16:23], v250
    v_exp_f32 v26, v26
    v_exp_f32 v27, v27
    v_exp_f32 v28, v28
    v_exp_f32 v29, v29
    v_exp_f32 v30, v30
    v_exp_f32 v31, v31
    v_exp_f32 v32, v32
    v_exp_f32 v33, v33
    v_smfmac_f32_32x32x32_bf16 v[48:63], v[220:223], v[24:31], v250
    v_exp_f32 v34, v34
    v_exp_f32 v35, v35
    v_exp_f32 v36, v36
    v_mfma_f32_32x32x16_bf16 v[16:31], v[120:123], v[4:7], 0
    v_exp_f32 v37, v37
    v_exp_f32 v38, v38
    v_exp_f32 v39, v39
    v_exp_f32 v40, v40
    v_exp_f32 v41, v41
    v_smfmac_f32_32x32x32_bf16 v[64:79], v[196:199], v[32:39], v250
    v_exp_f32 v42, v42
    v_exp_f32 v43, v43
    v_exp_f32 v44, v44
    v_exp_f32 v45, v45
    v_exp_f32 v46, v46
    v_exp_f32 v47, v47
    s_setprio 0
    s_mov_b64 exec, s[62:63]
    buffer_load_dwordx4 v[232:235], v249, s[16:19], s60 offen offset:512 sc1
    s_add_u32 s59, s59, 2048
    s_and_b32 s59, s59, 0xffff
    s_add_u32 s60, s59, s58
    buffer_load_dwordx4 v[212:215], v249, s[16:19], s60 offen sc1
    s_mov_b64 exec, -1
    buffer_load_dwordx4 v[132:135], v248, s[16:19], s60 offen sc1
    s_mov_b64 exec, s[62:63]
    buffer_load_dwordx4 v[236:239], v249, s[16:19], s60 offen offset:512 sc1
    s_add_u32 s59, s59, 2048
    s_and_b32 s59, s59, 0xffff
    s_add_u32 s60, s59, s58
    buffer_load_dwordx4 v[192:195], v249, s[16:19], s60 offen sc1
    s_mov_b64 exec, -1
    buffer_load_dwordx4 v[112:115], v248, s[16:19], s60 offen sc1
    s_waitcnt vmcnt(9)
    s_setprio 1
    v_exp_f32 v16, v16
    s_setprio 2
    v_exp_f32 v17, v17
    v_smfmac_f32_32x32x32_bf16 v[64:79], v[220:223], v[40:47], v250
    v_exp_f32 v18, v18
    v_exp_f32 v19, v19
    v_exp_f32 v20, v20
    v_mfma_f32_32x32x16_bf16 v[32:47], v[120:123], v[8:11], 0
    v_exp_f32 v21, v21
    v_exp_f32 v22, v22
    v_exp_f32 v23, v23
    v_exp_f32 v24, v24
    v_exp_f32 v25, v25
    v_smfmac_f32_32x32x32_bf16 v[48:63], v[200:203], v[16:23], v250
    v_exp_f32 v26, v26
    v_exp_f32 v27, v27
    v_exp_f32 v28, v28
    v_exp_f32 v29, v29
    v_exp_f32 v30, v30
    v_exp_f32 v31, v31
    v_exp_f32 v32, v32
    v_exp_f32 v33, v33
    v_smfmac_f32_32x32x32_bf16 v[48:63], v[224:227], v[24:31], v250
    v_exp_f32 v34, v34
    v_exp_f32 v35, v35
    v_exp_f32 v36, v36
    v_mfma_f32_32x32x16_bf16 v[16:31], v[124:127], v[4:7], 0
    v_exp_f32 v37, v37
    v_exp_f32 v38, v38
    v_exp_f32 v39, v39
    v_exp_f32 v40, v40
    v_exp_f32 v41, v41
    v_smfmac_f32_32x32x32_bf16 v[64:79], v[200:203], v[32:39], v250
    v_exp_f32 v42, v42
    v_exp_f32 v43, v43
    v_exp_f32 v44, v44
    v_exp_f32 v45, v45
    v_exp_f32 v46, v46
    v_exp_f32 v47, v47
    s_setprio 0
    s_mov_b64 exec, s[62:63]
    buffer_load_dwordx4 v[216:219], v249, s[16:19], s60 offen offset:512 sc1
    s_add_u32 s59, s59, 2048
    s_and_b32 s59, s59, 0xffff
    s_add_u32 s60, s59, s58
    buffer_load_dwordx4 v[196:199], v249, s[16:19], s60 offen sc1
    s_mov_b64 exec, -1
    buffer_load_dwordx4 v[116:119], v248, s[16:19], s60 offen sc1
    s_mov_b64 exec, s[62:63]
    buffer_load_dwordx4 v[220:223], v249, s[16:19], s60 offen offset:512 sc1
    s_add_u32 s59, s59, 2048
    s_and_b32 s59, s59, 0xffff
    s_add_u32 s60, s59, s58
    buffer_load_dwordx4 v[200:203], v249, s[16:19], s60 offen sc1
    s_mov_b64 exec, -1
    buffer_load_dwordx4 v[120:123], v248, s[16:19], s60 offen sc1
    s_waitcnt vmcnt(12)
    s_setprio 1
    v_exp_f32 v16, v16
    s_setprio 2
    v_exp_f32 v17, v17
    v_smfmac_f32_32x32x32_bf16 v[64:79], v[224:227], v[40:47], v250
    v_exp_f32 v18, v18
    v_exp_f32 v19, v19
    v_exp_f32 v20, v20
    v_mfma_f32_32x32x16_bf16 v[32:47], v[124:127], v[8:11], 0
    v_exp_f32 v21, v21
    v_exp_f32 v22, v22
    v_exp_f32 v23, v23
    v_exp_f32 v24, v24
    v_exp_f32 v25, v25
    v_smfmac_f32_32x32x32_bf16 v[48:63], v[204:207], v[16:23], v250
    v_exp_f32 v26, v26
    v_exp_f32 v27, v27
    v_exp_f32 v28, v28
    v_exp_f32 v29, v29
    v_exp_f32 v30, v30
    v_exp_f32 v31, v31
    v_exp_f32 v32, v32
    v_exp_f32 v33, v33
    v_smfmac_f32_32x32x32_bf16 v[48:63], v[228:231], v[24:31], v250
    v_exp_f32 v34, v34
    v_exp_f32 v35, v35
    v_exp_f32 v36, v36
    v_mfma_f32_32x32x16_bf16 v[16:31], v[128:131], v[4:7], 0
    v_exp_f32 v37, v37
    v_exp_f32 v38, v38
    v_exp_f32 v39, v39
    v_exp_f32 v40, v40
    v_exp_f32 v41, v41
    v_smfmac_f32_32x32x32_bf16 v[64:79], v[204:207], v[32:39], v250
    v_exp_f32 v42, v42
    v_exp_f32 v43, v43
    v_exp_f32 v44, v44
    v_exp_f32 v45, v45
    v_exp_f32 v46, v46
    v_exp_f32 v47, v47
    s_setprio 0
    s_mov_b64 exec, s[62:63]
    buffer_load_dwordx4 v[224:227], v249, s[16:19], s60 offen offset:512 sc1
    s_add_u32 s59, s59, 2048
    s_and_b32 s59, s59, 0xffff
    s_add_u32 s60, s59, s58
    buffer_load_dwordx4 v[204:207], v249, s[16:19], s60 offen sc1
    s_mov_b64 exec, -1
    buffer_load_dwordx4 v[124:127], v248, s[16:19], s60 offen sc1
    s_lshl_b32 s57, s98, 1
    s_add_u32 s57, s57, s47
    s_mul_i32 s57, s57, 4096
    s_add_u32 s57, s57, 11534336
    s_cmp_lt_u32 s47, 2
    s_cbranch_scc0 L_at_19
    s_add_u32 s49, s57, 0
    buffer_atomic_add_f32 v144, v154, s[16:19], s49 offen
    s_add_u32 s49, s57, 128
    buffer_atomic_add_f32 v145, v154, s[16:19], s49 offen
    s_add_u32 s49, s57, 256
    buffer_atomic_add_f32 v146, v154, s[16:19], s49 offen
    s_add_u32 s49, s57, 384
    buffer_atomic_add_f32 v147, v154, s[16:19], s49 offen
    s_add_u32 s49, s57, 512
    buffer_atomic_add_f32 v148, v154, s[16:19], s49 offen
    s_add_u32 s49, s57, 640
    buffer_atomic_add_f32 v149, v154, s[16:19], s49 offen
    s_add_u32 s49, s57, 768
    buffer_atomic_add_f32 v150, v154, s[16:19], s49 offen
    s_add_u32 s49, s57, 896
    buffer_atomic_add_f32 v151, v154, s[16:19], s49 offen
    s_mov_b64 exec, 0xffffffff
    s_add_u32 s49, s57, 1024
    buffer_atomic_add_f32 v152, v153, s[16:19], s49 offen
    s_branch L_atj_20
L_at_19:
    s_mov_b64 exec, 1
L_atj_20:
    s_mov_b64 exec, -1
    s_waitcnt vmcnt(21)
    s_cmp_lt_u32 s47, 2
    s_cbranch_scc1 L_vw_21
    s_waitcnt vmcnt(12)
L_vw_21:
    s_setprio 1
    v_exp_f32 v16, v16
    s_setprio 2
    v_exp_f32 v17, v17
    v_smfmac_f32_32x32x32_bf16 v[64:79], v[228:231], v[40:47], v250
    v_exp_f32 v18, v18
    v_exp_f32 v19, v19
    v_exp_f32 v20, v20
    v_mfma_f32_32x32x16_bf16 v[32:47], v[128:131], v[8:11], 0
    v_exp_f32 v21, v21
    v_exp_f32 v22, v22
    v_exp_f32 v23, v23
    v_exp_f32 v24, v24
    v_exp_f32 v25, v25
    v_smfmac_f32_32x32x32_bf16 v[48:63], v[208:211], v[16:23], v250
    v_exp_f32 v26, v26
    v_exp_f32 v27, v27
    v_exp_f32 v28, v28
    v_exp_f32 v29, v29
    v_exp_f32 v30, v30
    v_exp_f32 v31, v31
    v_exp_f32 v32, v32
    v_exp_f32 v33, v33
    v_smfmac_f32_32x32x32_bf16 v[48:63], v[232:235], v[24:31], v250
    v_exp_f32 v34, v34
    v_exp_f32 v35, v35
    v_exp_f32 v36, v36
    v_mfma_f32_32x32x16_bf16 v[16:31], v[132:135], v[4:7], 0
    v_exp_f32 v37, v37
    v_exp_f32 v38, v38
    v_exp_f32 v39, v39
    v_exp_f32 v40, v40
    v_exp_f32 v41, v41
    v_smfmac_f32_32x32x32_bf16 v[64:79], v[208:211], v[32:39], v250
    v_exp_f32 v42, v42
    v_exp_f32 v43, v43
    v_exp_f32 v44, v44
    v_exp_f32 v45, v45
    v_exp_f32 v46, v46
    v_exp_f32 v47, v47
    s_setprio 0
    s_mov_b64 exec, s[62:63]
    buffer_load_dwordx4 v[228:231], v249, s[16:19], s60 offen offset:512 sc1
    s_add_u32 s59, s59, 2048
    s_and_b32 s59, s59, 0xffff
    s_add_u32 s60, s59, s58
    buffer_load_dwordx4 v[208:211], v249, s[16:19], s60 offen sc1
    s_mov_b64 exec, -1
    buffer_load_dwordx4 v[128:131], v248, s[16:19], s60 offen sc1
    s_waitcnt vmcnt(21)
    s_cmp_lt_u32 s47, 2
    s_cbranch_scc1 L_vw_22
    s_waitcnt vmcnt(12)
L_vw_22:
    s_setprio 1
    v_exp_f32 v16, v16
    s_setprio 2
    v_exp_f32 v17, v17
    v_smfmac_f32_32x32x32_bf16 v[64:79], v[232:235], v[40:47], v250
    v_exp_f32 v18, v18
    v_exp_f32 v19, v19
    v_exp_f32 v20, v20
    v_mfma_f32_32x32x16_bf16 v[32:47], v[132:135], v[8:11], 0
    v_exp_f32 v21, v21
    v_exp_f32 v22, v22
    v_exp_f32 v23, v23
    v_exp_f32 v24, v24
    v_exp_f32 v25, v25
    v_smfmac_f32_32x32x32_bf16 v[48:63], v[212:215], v[16:23], v250
    v_exp_f32 v26, v26
    v_exp_f32 v27, v27
    v_exp_f32 v28, v28
    v_exp_f32 v29, v29
    v_exp_f32 v30, v30
    v_exp_f32 v31, v31
    v_exp_f32 v32, v32
    v_exp_f32 v33, v33
    v_smfmac_f32_32x32x32_bf16 v[48:63], v[236:239], v[24:31], v250
    v_exp_f32 v34, v34
    v_exp_f32 v35, v35
    v_exp_f32 v36, v36
    v_mfma_f32_32x32x16_bf16 v[16:31], v[112:115], v[4:7], 0
    v_exp_f32 v37, v37
    v_exp_f32 v38, v38
    v_exp_f32 v39, v39
    v_exp_f32 v40, v40
    v_exp_f32 v41, v41
    v_smfmac_f32_32x32x32_bf16 v[64:79], v[212:215], v[32:39], v250
    v_exp_f32 v42, v42
    v_exp_f32 v43, v43
    v_exp_f32 v44, v44
    v_exp_f32 v45, v45
    v_exp_f32 v46, v46
    v_exp_f32 v47, v47
    s_setprio 0
    s_mov_b64 exec, s[62:63]
    buffer_load_dwordx4 v[232:235], v249, s[16:19], s60 offen offset:512 sc1
    s_add_u32 s59, s59, 2048
    s_and_b32 s59, s59, 0xffff
    s_add_u32 s60, s59, s58
    buffer_load_dwordx4 v[212:215], v249, s[16:19], s60 offen sc1
    s_mov_b64 exec, -1
    buffer_load_dwordx4 v[132:135], v248, s[16:19], s60 offen sc1
    s_waitcnt vmcnt(21)
    s_cmp_lt_u32 s47, 2
    s_cbranch_scc1 L_vw_23
    s_waitcnt vmcnt(12)
L_vw_23:
    s_setprio 1
    v_exp_f32 v16, v16
    s_setprio 2
    v_exp_f32 v17, v17
    v_smfmac_f32_32x32x32_bf16 v[64:79], v[236:239], v[40:47], v250
    v_exp_f32 v18, v18
    v_exp_f32 v19, v19
    v_exp_f32 v20, v20
    v_mfma_f32_32x32x16_bf16 v[32:47], v[112:115], v[8:11], 0
    v_exp_f32 v21, v21
    v_exp_f32 v22, v22
    v_exp_f32 v23, v23
    v_exp_f32 v24, v24
    v_exp_f32 v25, v25
    v_smfmac_f32_32x32x32_bf16 v[48:63], v[192:195], v[16:23], v250
    v_exp_f32 v26, v26
    v_exp_f32 v27, v27
    v_exp_f32 v28, v28
    v_exp_f32 v29, v29
    v_exp_f32 v30, v30
    v_exp_f32 v31, v31
    v_exp_f32 v32, v32
    v_exp_f32 v33, v33
    v_smfmac_f32_32x32x32_bf16 v[48:63], v[216:219], v[24:31], v250
    v_exp_f32 v34, v34
    v_exp_f32 v35, v35
    v_exp_f32 v36, v36
    v_mfma_f32_32x32x16_bf16 v[16:31], v[116:119], v[4:7], 0
    v_exp_f32 v37, v37
    v_exp_f32 v38, v38
    v_exp_f32 v39, v39
    v_exp_f32 v40, v40
    v_exp_f32 v41, v41
    v_smfmac_f32_32x32x32_bf16 v[64:79], v[192:195], v[32:39], v250
    v_exp_f32 v42, v42
    v_exp_f32 v43, v43
    v_exp_f32 v44, v44
    v_exp_f32 v45, v45
    v_exp_f32 v46, v46
    v_exp_f32 v47, v47
    s_setprio 0
    s_mov_b64 exec, s[62:63]
    buffer_load_dwordx4 v[236:239], v249, s[16:19], s60 offen offset:512 sc1
    s_add_u32 s59, s59, 2048
    s_and_b32 s59, s59, 0xffff
    s_add_u32 s60, s59, s58
    buffer_load_dwordx4 v[192:195], v249, s[16:19], s60 offen sc1
    s_mov_b64 exec, -1
    buffer_load_dwordx4 v[112:115], v248, s[16:19], s60 offen sc1
    s_lshl_b32 s55, s47, 13
    s_lshl_b32 s56, s47, 16
    s_lshl_b32 s50, s97, 7
    s_add_u32 s56, s56, s50
    s_mov_b32 s22, 0x80000
    s_and_b32 s49, s96, 6
    s_lshl_b32 s49, s49, 1
    s_add_u32 s49, s49, 0
    s_and_b32 s50, s49, 7
    s_bitcmp1_b32 s49, 3
    s_cselect_b32 s20, s24, s28
    s_cselect_b32 s21, s25, s29
    s_cselect_b32 s49, 81920, 0
    s_add_u32 s49, s49, s55
    s_lshl_b32 s51, s50, 10
    s_add_u32 m0, s49, s51
    s_lshl_b32 s50, s50, 13
    s_add_u32 s50, s50, s56
    buffer_load_dwordx4 v240, s[20:23], s50 offen lds
    s_waitcnt vmcnt(22)
    s_cmp_lt_u32 s47, 2
    s_cbranch_scc1 L_vw_24
    s_waitcnt vmcnt(13)
L_vw_24:
    s_setprio 1
    v_exp_f32 v16, v16
    s_setprio 2
    v_exp_f32 v17, v17
    v_smfmac_f32_32x32x32_bf16 v[64:79], v[216:219], v[40:47], v250
    v_exp_f32 v18, v18
    v_exp_f32 v19, v19
    v_exp_f32 v20, v20
    v_mfma_f32_32x32x16_bf16 v[32:47], v[116:119], v[8:11], 0
    v_exp_f32 v21, v21
    v_exp_f32 v22, v22
    v_exp_f32 v23, v23
    v_exp_f32 v24, v24
    v_exp_f32 v25, v25
    v_smfmac_f32_32x32x32_bf16 v[48:63], v[196:199], v[16:23], v250
    v_exp_f32 v26, v26
    v_exp_f32 v27, v27
    v_exp_f32 v28, v28
    v_exp_f32 v29, v29
    v_exp_f32 v30, v30
    v_exp_f32 v31, v31
    v_exp_f32 v32, v32
    v_exp_f32 v33, v33
    v_smfmac_f32_32x32x32_bf16 v[48:63], v[220:223], v[24:31], v250
    v_exp_f32 v34, v34
    v_exp_f32 v35, v35
    v_exp_f32 v36, v36
    v_mfma_f32_32x32x16_bf16 v[16:31], v[120:123], v[4:7], 0
    v_exp_f32 v37, v37
    v_exp_f32 v38, v38
    v_exp_f32 v39, v39
    v_exp_f32 v40, v40
    v_exp_f32 v41, v41
    v_smfmac_f32_32x32x32_bf16 v[64:79], v[196:199], v[32:39], v250
    v_exp_f32 v42, v42
    v_exp_f32 v43, v43
    v_exp_f32 v44, v44
    v_exp_f32 v45, v45
    v_exp_f32 v46, v46
    v_exp_f32 v47, v47
    s_setprio 0
    s_mov_b64 exec, s[62:63]
    buffer_load_dwordx4 v[216:219], v249, s[16:19], s60 offen offset:512 sc1
    s_add_u32 s59, s59, 2048
    s_and_b32 s59, s59, 0xffff
    s_add_u32 s60, s59, s58
    buffer_load_dwordx4 v[196:199], v249, s[16:19], s60 offen sc1
    s_mov_b64 exec, -1
    buffer_load_dwordx4 v[116:119], v248, s[16:19], s60 offen sc1
    s_and_b32 s49, s96, 6
    s_lshl_b32 s49, s49, 1
    s_add_u32 s49, s49, 1
    s_and_b32 s50, s49, 7
    s_bitcmp1_b32 s49, 3
    s_cselect_b32 s20, s24, s28
    s_cselect_b32 s21, s25, s29
    s_cselect_b32 s49, 81920, 0
    s_add_u32 s49, s49, s55
    s_lshl_b32 s51, s50, 10
    s_add_u32 m0, s49, s51
    s_lshl_b32 s50, s50, 13
    s_add_u32 s50, s50, s56
    buffer_load_dwordx4 v240, s[20:23], s50 offen lds
    s_waitcnt vmcnt(23)
    s_cmp_lt_u32 s47, 2
    s_cbranch_scc1 L_vw_25
    s_waitcnt vmcnt(14)
L_vw_25:
    s_setprio 1
    v_exp_f32 v16, v16
    s_setprio 2
    v_exp_f32 v17, v17
    v_smfmac_f32_32x32x32_bf16 v[64:79], v[220:223], v[40:47], v250
    v_exp_f32 v18, v18
    v_exp_f32 v19, v19
    v_exp_f32 v20, v20
    v_mfma_f32_32x32x16_bf16 v[32:47], v[120:123], v[8:11], 0
    v_exp_f32 v21, v21
    v_exp_f32 v22, v22
    v_exp_f32 v23, v23
    v_exp_f32 v24, v24
    v_exp_f32 v25, v25
    v_smfmac_f32_32x32x32_bf16 v[48:63], v[200:203], v[16:23], v250
    v_exp_f32 v26, v26
    v_exp_f32 v27, v27
    v_exp_f32 v28, v28
    v_exp_f32 v29, v29
    v_exp_f32 v30, v30
    v_exp_f32 v31, v31
    v_exp_f32 v32, v32
    v_exp_f32 v33, v33
    v_smfmac_f32_32x32x32_bf16 v[48:63], v[224:227], v[24:31], v250
    v_exp_f32 v34, v34
    v_exp_f32 v35, v35
    v_exp_f32 v36, v36
    v_mfma_f32_32x32x16_bf16 v[16:31], v[124:127], v[4:7], 0
    v_exp_f32 v37, v37
    v_exp_f32 v38, v38
    v_exp_f32 v39, v39
    v_exp_f32 v40, v40
    v_exp_f32 v41, v41
    v_smfmac_f32_32x32x32_bf16 v[64:79], v[200:203], v[32:39], v250
    v_exp_f32 v42, v42
    v_exp_f32 v43, v43
    v_exp_f32 v44, v44
    v_exp_f32 v45, v45
    v_exp_f32 v46, v46
    v_exp_f32 v47, v47
    s_setprio 0
    s_mov_b64 exec, s[62:63]
    buffer_load_dwordx4 v[220:223], v249, s[16:19], s60 offen offset:512 sc1
    s_add_u32 s59, s59, 2048
    s_and_b32 s59, s59, 0xffff
    s_add_u32 s60, s59, s58
    buffer_load_dwordx4 v[200:203], v249, s[16:19], s60 offen sc1
    s_mov_b64 exec, -1
    buffer_load_dwordx4 v[120:123], v248, s[16:19], s60 offen sc1
    s_and_b32 s49, s96, 6
    s_lshl_b32 s49, s49, 1
    s_add_u32 s49, s49, 2
    s_and_b32 s50, s49, 7
    s_bitcmp1_b32 s49, 3
    s_cselect_b32 s20, s24, s28
    s_cselect_b32 s21, s25, s29
    s_cselect_b32 s49, 81920, 0
    s_add_u32 s49, s49, s55
    s_lshl_b32 s51, s50, 10
    s_add_u32 m0, s49, s51
    s_lshl_b32 s50, s50, 13
    s_add_u32 s50, s50, s56
    buffer_load_dwordx4 v240, s[20:23], s50 offen lds
    s_waitcnt vmcnt(15)
    s_setprio 1
    v_exp_f32 v16, v16
    s_setprio 2
    v_exp_f32 v17, v17
    v_smfmac_f32_32x32x32_bf16 v[64:79], v[224:227], v[40:47], v250
    v_exp_f32 v18, v18
    v_exp_f32 v19, v19
    v_exp_f32 v20, v20
    v_mfma_f32_32x32x16_bf16 v[32:47], v[124:127], v[8:11], 0
    v_exp_f32 v21, v21
    v_exp_f32 v22, v22
    v_exp_f32 v23, v23
    v_exp_f32 v24, v24
    v_exp_f32 v25, v25
    v_smfmac_f32_32x32x32_bf16 v[48:63], v[204:207], v[16:23], v250
    v_exp_f32 v26, v26
    v_exp_f32 v27, v27
    v_exp_f32 v28, v28
    v_exp_f32 v29, v29
    v_exp_f32 v30, v30
    v_exp_f32 v31, v31
    v_exp_f32 v32, v32
    v_exp_f32 v33, v33
    v_smfmac_f32_32x32x32_bf16 v[48:63], v[228:231], v[24:31], v250
    v_exp_f32 v34, v34
    v_exp_f32 v35, v35
    v_exp_f32 v36, v36
    v_mfma_f32_32x32x16_bf16 v[16:31], v[128:131], v[4:7], 0
    v_exp_f32 v37, v37
    v_exp_f32 v38, v38
    v_exp_f32 v39, v39
    v_exp_f32 v40, v40
    v_exp_f32 v41, v41
    v_smfmac_f32_32x32x32_bf16 v[64:79], v[204:207], v[32:39], v250
    v_exp_f32 v42, v42
    v_exp_f32 v43, v43
    v_exp_f32 v44, v44
    v_exp_f32 v45, v45
    v_exp_f32 v46, v46
    v_exp_f32 v47, v47
    s_setprio 0
    s_mov_b64 exec, s[62:63]
    buffer_load_dwordx4 v[224:227], v249, s[16:19], s60 offen offset:512 sc1
    s_add_u32 s59, s59, 2048
    s_and_b32 s59, s59, 0xffff
    s_add_u32 s60, s59, s58
    buffer_load_dwordx4 v[204:207], v249, s[16:19], s60 offen sc1
    s_mov_b64 exec, -1
    buffer_load_dwordx4 v[124:127], v248, s[16:19], s60 offen sc1
    s_and_b32 s49, s96, 6
    s_lshl_b32 s49, s49, 1
    s_add_u32 s49, s49, 3
    s_and_b32 s50, s49, 7
    s_bitcmp1_b32 s49, 3
    s_cselect_b32 s20, s24, s28
    s_cselect_b32 s21, s25, s29
    s_cselect_b32 s49, 81920, 0
    s_add_u32 s49, s49, s55
    s_lshl_b32 s51, s50, 10
    s_add_u32 m0, s49, s51
    s_lshl_b32 s50, s50, 13
    s_add_u32 s50, s50, s56
    buffer_load_dwordx4 v240, s[20:23], s50 offen lds
    s_waitcnt vmcnt(16)
    s_setprio 1
    v_exp_f32 v16, v16
    s_setprio 2
    v_exp_f32 v17, v17
    v_smfmac_f32_32x32x32_bf16 v[64:79], v[228:231], v[40:47], v250
    v_exp_f32 v18, v18
    v_exp_f32 v19, v19
    v_exp_f32 v20, v20
    v_mfma_f32_32x32x16_bf16 v[32:47], v[128:131], v[8:11], 0
    v_exp_f32 v21, v21
    v_exp_f32 v22, v22
    v_exp_f32 v23, v23
    v_exp_f32 v24, v24
    v_exp_f32 v25, v25
    v_smfmac_f32_32x32x32_bf16 v[48:63], v[208:211], v[16:23], v250
    v_exp_f32 v26, v26
    v_exp_f32 v27, v27
    v_exp_f32 v28, v28
    v_exp_f32 v29, v29
    v_exp_f32 v30, v30
    v_exp_f32 v31, v31
    v_exp_f32 v32, v32
    v_exp_f32 v33, v33
    v_smfmac_f32_32x32x32_bf16 v[48:63], v[232:235], v[24:31], v250
    v_exp_f32 v34, v34
    v_exp_f32 v35, v35
    v_exp_f32 v36, v36
    v_mfma_f32_32x32x16_bf16 v[16:31], v[132:135], v[4:7], 0
    v_exp_f32 v37, v37
    v_exp_f32 v38, v38
    v_exp_f32 v39, v39
    v_exp_f32 v40, v40
    v_exp_f32 v41, v41
    v_smfmac_f32_32x32x32_bf16 v[64:79], v[208:211], v[32:39], v250
    v_exp_f32 v42, v42
    v_exp_f32 v43, v43
    v_exp_f32 v44, v44
    v_exp_f32 v45, v45
    v_exp_f32 v46, v46
    v_exp_f32 v47, v47
    s_setprio 0
    s_mov_b64 exec, s[62:63]
    buffer_load_dwordx4 v[228:231], v249, s[16:19], s60 offen offset:512 sc1
    s_add_u32 s59, s59, 2048
    s_and_b32 s59, s59, 0xffff
    s_add_u32 s60, s59, s58
    buffer_load_dwordx4 v[208:211], v249, s[16:19], s60 offen sc1
    s_mov_b64 exec, -1
    buffer_load_dwordx4 v[128:131], v248, s[16:19], s60 offen sc1
    s_and_b32 s49, s96, 6
    s_lshl_b32 s49, s49, 1
    s_add_u32 s49, s49, 4
    s_and_b32 s50, s49, 7
    s_bitcmp1_b32 s49, 3
    s_cselect_b32 s20, s24, s28
    s_cselect_b32 s21, s25, s29
    s_cselect_b32 s49, 81920, 0
    s_add_u32 s49, s49, s55
    s_lshl_b32 s51, s50, 10
    s_add_u32 m0, s49, s51
    s_lshl_b32 s50, s50, 13
    s_add_u32 s50, s50, s56
    buffer_load_dwordx4 v240, s[20:23], s50 offen lds
    s_waitcnt vmcnt(26)
    s_cmp_lt_u32 s47, 2
    s_cbranch_scc0 L_fp_26
    s_lshl_b32 s49, s98, 1
    s_add_u32 s49, s49, s47
    s_lshl_b32 s49, s49, 5
    s_add_u32 s49, s49, s45
    s_lshl_b32 s49, s49, 7
    s_add_u32 s49, s49, 9469952
    s_mov_b64 exec, 1
    buffer_store_dword v136, v137, s[16:19], s49 offen sc1
    s_mov_b64 exec, -1
L_fp_26:
    s_waitcnt vmcnt(18)
    s_cmp_lt_u32 s47, 2
    s_cbranch_scc1 L_vw_27
    s_waitcnt vmcnt(17)
L_vw_27:
    s_setprio 1
    v_exp_f32 v16, v16
    s_setprio 2
    v_exp_f32 v17, v17
    v_smfmac_f32_32x32x32_bf16 v[64:79], v[232:235], v[40:47], v250
    v_exp_f32 v18, v18
    v_exp_f32 v19, v19
    v_exp_f32 v20, v20
    v_mfma_f32_32x32x16_bf16 v[32:47], v[132:135], v[8:11], 0
    v_exp_f32 v21, v21
    v_exp_f32 v22, v22
    v_exp_f32 v23, v23
    v_exp_f32 v24, v24
    v_exp_f32 v25, v25
    v_smfmac_f32_32x32x32_bf16 v[48:63], v[212:215], v[16:23], v250
    v_exp_f32 v26, v26
    v_exp_f32 v27, v27
    v_exp_f32 v28, v28
    v_exp_f32 v29, v29
    v_exp_f32 v30, v30
    v_exp_f32 v31, v31
    v_exp_f32 v32, v32
    v_exp_f32 v33, v33
    v_smfmac_f32_32x32x32_bf16 v[48:63], v[236:239], v[24:31], v250
    v_exp_f32 v34, v34
    v_exp_f32 v35, v35
    v_exp_f32 v36, v36
    v_mfma_f32_32x32x16_bf16 v[16:31], v[112:115], v[4:7], 0
    v_exp_f32 v37, v37
    v_exp_f32 v38, v38
    v_exp_f32 v39, v39
    v_exp_f32 v40, v40
    v_exp_f32 v41, v41
    v_smfmac_f32_32x32x32_bf16 v[64:79], v[212:215], v[32:39], v250
    v_exp_f32 v42, v42
    v_exp_f32 v43, v43
    v_exp_f32 v44, v44
    v_exp_f32 v45, v45
    v_exp_f32 v46, v46
    v_exp_f32 v47, v47
    s_setprio 0
    s_mov_b64 exec, s[62:63]
    buffer_load_dwordx4 v[232:235], v249, s[16:19], s60 offen offset:512 sc1
    s_add_u32 s59, s59, 2048
    s_and_b32 s59, s59, 0xffff
    s_add_u32 s60, s59, s58
    buffer_load_dwordx4 v[212:215], v249, s[16:19], s60 offen sc1
    s_mov_b64 exec, -1
    buffer_load_dwordx4 v[132:135], v248, s[16:19], s60 offen sc1
    s_and_b32 s49, s96, 6
    s_lshl_b32 s49, s49, 1
    s_add_u32 s49, s49, 5
    s_and_b32 s50, s49, 7
    s_bitcmp1_b32 s49, 3
    s_cselect_b32 s20, s24, s28
    s_cselect_b32 s21, s25, s29
    s_cselect_b32 s49, 81920, 0
    s_add_u32 s49, s49, s55
    s_lshl_b32 s51, s50, 10
    s_add_u32 m0, s49, s51
    s_lshl_b32 s50, s50, 13
    s_add_u32 s50, s50, s56
    buffer_load_dwordx4 v240, s[20:23], s50 offen lds
    s_and_b32 s49, s68, 7
    s_xor_b32 s49, s49, s44
    s_lshl_b32 s49, s49, 2
    s_add_u32 s49, s49, s66
    s_lshl_b32 s49, s49, 10
    s_lshl_b32 s51, s68, 15
    s_add_u32 s51, s51, s49
    s_add_u32 s51, s51, 7340032
    buffer_store_dwordx4 v[176:179], v248, s[16:19], s51 offen sc1
    s_waitcnt vmcnt(19)
    s_cmp_lt_u32 s47, 2
    s_cbranch_scc1 L_vw_28
    s_waitcnt vmcnt(18)
L_vw_28:
    s_setprio 1
    v_exp_f32 v16, v16
    s_setprio 2
    v_exp_f32 v17, v17
    v_smfmac_f32_32x32x32_bf16 v[64:79], v[236:239], v[40:47], v250
    v_exp_f32 v18, v18
    v_exp_f32 v19, v19
    v_exp_f32 v20, v20
    v_mfma_f32_32x32x16_bf16 v[32:47], v[112:115], v[8:11], 0
    v_exp_f32 v21, v21
    v_exp_f32 v22, v22
    v_exp_f32 v23, v23
    v_exp_f32 v24, v24
    v_exp_f32 v25, v25
    v_smfmac_f32_32x32x32_bf16 v[48:63], v[192:195], v[16:23], v250
    v_exp_f32 v26, v26
    v_exp_f32 v27, v27
    v_exp_f32 v28, v28
    v_exp_f32 v29, v29
    v_exp_f32 v30, v30
    v_exp_f32 v31, v31
    v_exp_f32 v32, v32
    v_exp_f32 v33, v33
    v_smfmac_f32_32x32x32_bf16 v[48:63], v[216:219], v[24:31], v250
    v_exp_f32 v34, v34
    v_exp_f32 v35, v35
    v_exp_f32 v36, v36
    v_mfma_f32_32x32x16_bf16 v[16:31], v[116:119], v[4:7], 0
    v_exp_f32 v37, v37
    v_exp_f32 v38, v38
    v_exp_f32 v39, v39
    v_exp_f32 v40, v40
    v_exp_f32 v41, v41
    v_smfmac_f32_32x32x32_bf16 v[64:79], v[192:195], v[32:39], v250
    v_exp_f32 v42, v42
    v_exp_f32 v43, v43
    v_exp_f32 v44, v44
    v_exp_f32 v45, v45
    v_exp_f32 v46, v46
    v_exp_f32 v47, v47
    s_setprio 0
    s_mov_b64 exec, s[62:63]
    buffer_load_dwordx4 v[236:239], v249, s[16:19], s60 offen offset:512 sc1
    s_add_u32 s59, s59, 2048
    s_and_b32 s59, s59, 0xffff
    s_add_u32 s60, s59, s58
    buffer_load_dwordx4 v[192:195], v249, s[16:19], s60 offen sc1
    s_mov_b64 exec, -1
    buffer_load_dwordx4 v[112:115], v248, s[16:19], s60 offen sc1
    s_and_b32 s49, s96, 6
    s_lshl_b32 s49, s49, 1
    s_add_u32 s49, s49, 6
    s_and_b32 s50, s49, 7
    s_bitcmp1_b32 s49, 3
    s_cselect_b32 s20, s24, s28
    s_cselect_b32 s21, s25, s29
    s_cselect_b32 s49, 81920, 0
    s_add_u32 s49, s49, s55
    s_lshl_b32 s51, s50, 10
    s_add_u32 m0, s49, s51
    s_lshl_b32 s50, s50, 13
    s_add_u32 s50, s50, s56
    buffer_load_dwordx4 v240, s[20:23], s50 offen lds
    s_waitcnt vmcnt(19)
    s_cmp_lt_u32 s47, 2
    s_cbranch_scc1 L_vw_29
    s_waitcnt vmcnt(18)
L_vw_29:
    s_setprio 1
    v_exp_f32 v16, v16
    s_setprio 2
    v_exp_f32 v17, v17
    v_smfmac_f32_32x32x32_bf16 v[64:79], v[216:219], v[40:47], v250
    v_exp_f32 v18, v18
    v_exp_f32 v19, v19
    v_exp_f32 v20, v20
    v_mfma_f32_32x32x16_bf16 v[32:47], v[116:119], v[8:11], 0
    v_exp_f32 v21, v21
    v_exp_f32 v22, v22
    v_exp_f32 v23, v23
    v_exp_f32 v24, v24
    v_exp_f32 v25, v25
    v_smfmac_f32_32x32x32_bf16 v[48:63], v[196:199], v[16:23], v250
    v_exp_f32 v26, v26
    v_exp_f32 v27, v27
    v_exp_f32 v28, v28
    v_exp_f32 v29, v29
    v_exp_f32 v30, v30
    v_exp_f32 v31, v31
    v_exp_f32 v32, v32
    v_exp_f32 v33, v33
    v_smfmac_f32_32x32x32_bf16 v[48:63], v[220:223], v[24:31], v250
    v_exp_f32 v34, v34
    v_exp_f32 v35, v35
    v_exp_f32 v36, v36
    v_mfma_f32_32x32x16_bf16 v[16:31], v[120:123], v[4:7], 0
    v_exp_f32 v37, v37
    v_exp_f32 v38, v38
    v_exp_f32 v39, v39
    v_exp_f32 v40, v40
    v_exp_f32 v41, v41
    v_smfmac_f32_32x32x32_bf16 v[64:79], v[196:199], v[32:39], v250
    v_exp_f32 v42, v42
    v_exp_f32 v43, v43
    v_exp_f32 v44, v44
    v_exp_f32 v45, v45
    v_exp_f32 v46, v46
    v_exp_f32 v47, v47
    s_setprio 0
    s_mov_b64 exec, s[62:63]
    buffer_load_dwordx4 v[216:219], v249, s[16:19], s60 offen offset:512 sc1
    s_add_u32 s59, s59, 2048
    s_and_b32 s59, s59, 0xffff
    s_add_u32 s60, s59, s58
    buffer_load_dwordx4 v[196:199], v249, s[16:19], s60 offen sc1
    s_mov_b64 exec, -1
    buffer_load_dwordx4 v[116:119], v248, s[16:19], s60 offen sc1
    s_and_b32 s49, s96, 6
    s_lshl_b32 s49, s49, 1
    s_add_u32 s49, s49, 7
    s_and_b32 s50, s49, 7
    s_bitcmp1_b32 s49, 3
    s_cselect_b32 s20, s24, s28
    s_cselect_b32 s21, s25, s29
    s_cselect_b32 s49, 81920, 0
    s_add_u32 s49, s49, s55
    s_lshl_b32 s51, s50, 10
    s_add_u32 m0, s49, s51
    s_lshl_b32 s50, s50, 13
    s_add_u32 s50, s50, s56
    buffer_load_dwordx4 v240, s[20:23], s50 offen lds
    buffer_load_dword v253, v254, s[16:19], 0 offen sc1
    ds_read_b32 v244, v245
    s_waitcnt vmcnt(20)
    s_cmp_lt_u32 s47, 2
    s_cbranch_scc1 L_vw_30
    s_waitcnt vmcnt(19)
L_vw_30:
    s_setprio 1
    v_exp_f32 v16, v16
    s_setprio 2
    v_exp_f32 v17, v17
    v_smfmac_f32_32x32x32_bf16 v[64:79], v[220:223], v[40:47], v250
    v_exp_f32 v18, v18
    v_exp_f32 v19, v19
    v_exp_f32 v20, v20
    v_mfma_f32_32x32x16_bf16 v[32:47], v[120:123], v[8:11], 0
    v_exp_f32 v21, v21
    v_exp_f32 v22, v22
    v_exp_f32 v23, v23
    v_exp_f32 v24, v24
    v_exp_f32 v25, v25
    v_smfmac_f32_32x32x32_bf16 v[48:63], v[200:203], v[16:23], v250
    v_exp_f32 v26, v26
    v_exp_f32 v27, v27
    v_exp_f32 v28, v28
    v_exp_f32 v29, v29
    v_exp_f32 v30, v30
    v_exp_f32 v31, v31
    v_exp_f32 v32, v32
    v_exp_f32 v33, v33
    v_smfmac_f32_32x32x32_bf16 v[48:63], v[224:227], v[24:31], v250
    v_exp_f32 v34, v34
    v_exp_f32 v35, v35
    v_exp_f32 v36, v36
    v_mfma_f32_32x32x16_bf16 v[16:31], v[124:127], v[4:7], 0
    v_exp_f32 v37, v37
    v_exp_f32 v38, v38
    v_exp_f32 v39, v39
    v_exp_f32 v40, v40
    v_exp_f32 v41, v41
    v_smfmac_f32_32x32x32_bf16 v[64:79], v[200:203], v[32:39], v250
    v_exp_f32 v42, v42
    v_exp_f32 v43, v43
    v_exp_f32 v44, v44
    v_exp_f32 v45, v45
    v_exp_f32 v46, v46
    v_exp_f32 v47, v47
    s_setprio 0
    s_mov_b64 exec, s[62:63]
    buffer_load_dwordx4 v[220:223], v249, s[16:19], s60 offen offset:512 sc1
    s_add_u32 s59, s59, 2048
    s_and_b32 s59, s59, 0xffff
    s_add_u32 s60, s59, s58
    buffer_load_dwordx4 v[200:203], v249, s[16:19], s60 offen sc1
    s_mov_b64 exec, -1
    buffer_load_dwordx4 v[120:123], v248, s[16:19], s60 offen sc1
    s_and_b32 s49, s96, 6
    s_lshl_b32 s49, s49, 1
    s_add_u32 s49, s49, 8
    s_and_b32 s50, s49, 7
    s_bitcmp1_b32 s49, 3
    s_cselect_b32 s20, s24, s28
    s_cselect_b32 s21, s25, s29
    s_cselect_b32 s49, 81920, 0
    s_add_u32 s49, s49, s55
    s_lshl_b32 s51, s50, 10
    s_add_u32 m0, s49, s51
    s_lshl_b32 s50, s50, 13
    s_add_u32 s50, s50, s56
    buffer_load_dwordx4 v240, s[20:23], s50 offen lds
    s_waitcnt vmcnt(20)
    s_cmp_lt_u32 s47, 2
    s_cbranch_scc1 L_vw_31
    s_waitcnt vmcnt(19)
L_vw_31:
    s_setprio 1
    v_exp_f32 v16, v16
    s_setprio 2
    v_exp_f32 v17, v17
    v_smfmac_f32_32x32x32_bf16 v[64:79], v[224:227], v[40:47], v250
    v_exp_f32 v18, v18
    v_exp_f32 v19, v19
    v_exp_f32 v20, v20
    v_mfma_f32_32x32x16_bf16 v[32:47], v[124:127], v[8:11], 0
    v_exp_f32 v21, v21
    v_exp_f32 v22, v22
    v_exp_f32 v23, v23
    v_exp_f32 v24, v24
    v_exp_f32 v25, v25
    v_smfmac_f32_32x32x32_bf16 v[48:63], v[204:207], v[16:23], v250
    v_exp_f32 v26, v26
    v_exp_f32 v27, v27
    v_exp_f32 v28, v28
    v_exp_f32 v29, v29
    v_exp_f32 v30, v30
    v_exp_f32 v31, v31
    v_exp_f32 v32, v32
    v_exp_f32 v33, v33
    v_smfmac_f32_32x32x32_bf16 v[48:63], v[228:231], v[24:31], v250
    v_exp_f32 v34, v34
    v_exp_f32 v35, v35
    v_exp_f32 v36, v36
    v_mfma_f32_32x32x16_bf16 v[16:31], v[128:131], v[4:7], 0
    v_exp_f32 v37, v37
    v_exp_f32 v38, v38
    v_exp_f32 v39, v39
    v_exp_f32 v40, v40
    v_exp_f32 v41, v41
    v_smfmac_f32_32x32x32_bf16 v[64:79], v[204:207], v[32:39], v250
    v_exp_f32 v42, v42
    v_exp_f32 v43, v43
    v_exp_f32 v44, v44
    v_exp_f32 v45, v45
    v_exp_f32 v46, v46
    v_exp_f32 v47, v47
    s_setprio 3
    s_mov_b32 s65, 100000
L_pq_32:
    s_waitcnt lgkmcnt(0)
    v_readfirstlane_b32 s49, v244
    s_sub_u32 s65, s65, 1
    s_cbranch_scc1 L_pqok_33
    s_cmp_eq_u32 s49, 4
    s_cbranch_scc1 L_pqok_33
    ds_read_b32 v244, v245
    s_branch L_pq_32
L_pqok_33:
    s_waitcnt vmcnt(4)
    s_mov_b32 s65, 100000
L_fpw_34:
    v_cmp_ne_u32 vcc, s48, v253
    s_sub_u32 s65, s65, 1
    s_cbranch_vccz L_fpwok_35
    s_cbranch_scc1 L_fpwok_35
    buffer_load_dword v253, v254, s[16:19], 0 offen sc1
    s_waitcnt vmcnt(0)
    s_branch L_fpw_34
L_fpwok_35:
    s_setprio 0
    s_mov_b64 exec, s[62:63]
    buffer_load_dwordx4 v[224:227], v249, s[16:19], s60 offen offset:512 sc1
    s_add_u32 s59, s59, 2048
    s_and_b32 s59, s59, 0xffff
    s_add_u32 s60, s59, s58
    buffer_load_dwordx4 v[204:207], v249, s[16:19], s60 offen sc1
    s_mov_b64 exec, -1
    buffer_load_dwordx4 v[124:127], v248, s[16:19], s60 offen sc1
    s_and_b32 s49, s96, 6
    s_lshl_b32 s49, s49, 1
    s_add_u32 s49, s49, 9
    s_and_b32 s50, s49, 7
    s_bitcmp1_b32 s49, 3
    s_cselect_b32 s20, s24, s28
    s_cselect_b32 s21, s25, s29
    s_cselect_b32 s49, 81920, 0
    s_add_u32 s49, s49, s55
    s_lshl_b32 s51, s50, 10
    s_add_u32 m0, s49, s51
    s_lshl_b32 s50, s50, 13
    s_add_u32 s50, s50, s56
    buffer_load_dwordx4 v240, s[20:23], s50 offen lds
    ds_read_b128 v[12:15], v246 offset:8192
    ds_read_b32 v251, v247
    ds_read_b32 v252, v247 offset:256
    s_lshl_b32 s57, s44, 2
    s_add_u32 s57, s57, s66
    s_mul_i32 s57, s57, 2048
    s_add_u32 s57, s57, 11534336
    s_mov_b64 exec, s[62:63]
    s_add_u32 s49, s57, 0
    buffer_load_dword v80, v138, s[16:19], s49 offen sc1
    s_add_u32 s49, s57, 128
    buffer_load_dword v81, v138, s[16:19], s49 offen sc1
    s_add_u32 s49, s57, 256
    buffer_load_dword v82, v138, s[16:19], s49 offen sc1
    s_mov_b64 exec, -1
    s_waitcnt vmcnt(22)
    s_setprio 1
    v_exp_f32 v16, v16
    s_setprio 2
    v_exp_f32 v17, v17
    v_smfmac_f32_32x32x32_bf16 v[64:79], v[228:231], v[40:47], v250
    v_exp_f32 v18, v18
    v_exp_f32 v19, v19
    v_exp_f32 v20, v20
    v_mfma_f32_32x32x16_bf16 v[32:47], v[128:131], v[8:11], 0
    v_exp_f32 v21, v21
    v_exp_f32 v22, v22
    v_exp_f32 v23, v23
    v_exp_f32 v24, v24
    v_exp_f32 v25, v25
    v_smfmac_f32_32x32x32_bf16 v[48:63], v[208:211], v[16:23], v250
    v_exp_f32 v26, v26
    v_exp_f32 v27, v27
    v_exp_f32 v28, v28
    v_exp_f32 v29, v29
    v_exp_f32 v30, v30
    v_exp_f32 v31, v31
    v_exp_f32 v32, v32
    v_exp_f32 v33, v33
    v_smfmac_f32_32x32x32_bf16 v[48:63], v[232:235], v[24:31], v250
    v_exp_f32 v34, v34
    v_exp_f32 v35, v35
    v_exp_f32 v36, v36
    v_mfma_f32_32x32x16_bf16 v[16:31], v[132:135], v[4:7], 0
    v_exp_f32 v37, v37
    v_exp_f32 v38, v38
    v_exp_f32 v39, v39
    v_exp_f32 v40, v40
    v_exp_f32 v41, v41
    v_smfmac_f32_32x32x32_bf16 v[64:79], v[208:211], v[32:39], v250
    v_exp_f32 v42, v42
    v_exp_f32 v43, v43
    v_exp_f32 v44, v44
    v_exp_f32 v45, v45
    v_exp_f32 v46, v46
    v_exp_f32 v47, v47
    s_setprio 0
    s_mov_b64 exec, s[62:63]
    buffer_load_dwordx4 v[228:231], v249, s[16:19], s60 offen offset:512 sc1
    s_add_u32 s59, s59, 2048
    s_and_b32 s59, s59, 0xffff
    s_add_u32 s60, s59, s58
    buffer_load_dwordx4 v[208:211], v249, s[16:19], s60 offen sc1
    s_mov_b64 exec, -1
    buffer_load_dwordx4 v[128:131], v248, s[16:19], s60 offen sc1
    s_and_b32 s49, s96, 6
    s_lshl_b32 s49, s49, 1
    s_add_u32 s49, s49, 10
    s_and_b32 s50, s49, 7
    s_bitcmp1_b32 s49, 3
    s_cselect_b32 s20, s24, s28
    s_cselect_b32 s21, s25, s29
    s_cselect_b32 s49, 81920, 0
    s_add_u32 s49, s49, s55
    s_lshl_b32 s51, s50, 10
    s_add_u32 m0, s49, s51
    s_lshl_b32 s50, s50, 13
    s_add_u32 s50, s50, s56
    buffer_load_dwordx4 v240, s[20:23], s50 offen lds
    s_mov_b64 exec, s[62:63]
    s_add_u32 s49, s57, 384
    buffer_load_dword v83, v138, s[16:19], s49 offen sc1
    s_add_u32 s49, s57, 512
    buffer_load_dword v84, v138, s[16:19], s49 offen sc1
    s_add_u32 s49, s57, 640
    buffer_load_dword v85, v138, s[16:19], s49 offen sc1
    s_add_u32 s49, s57, 768
    buffer_load_dword v86, v138, s[16:19], s49 offen sc1
    s_mov_b64 exec, -1
    s_waitcnt vmcnt(25)
    s_setprio 1
    v_exp_f32 v16, v16
    s_setprio 2
    v_exp_f32 v17, v17
    v_smfmac_f32_32x32x32_bf16 v[64:79], v[232:235], v[40:47], v250
    v_exp_f32 v18, v18
    v_exp_f32 v19, v19
    v_exp_f32 v20, v20
    v_mfma_f32_32x32x16_bf16 v[32:47], v[132:135], v[8:11], 0
    v_exp_f32 v21, v21
    v_exp_f32 v22, v22
    v_exp_f32 v23, v23
    v_exp_f32 v24, v24
    v_exp_f32 v25, v25
    v_smfmac_f32_32x32x32_bf16 v[48:63], v[212:215], v[16:23], v250
    v_exp_f32 v26, v26
    v_exp_f32 v27, v27
    v_exp_f32 v28, v28
    v_exp_f32 v29, v29
    v_exp_f32 v30, v30
    v_exp_f32 v31, v31
    v_exp_f32 v32, v32
    v_exp_f32 v33, v33
    v_smfmac_f32_32x32x32_bf16 v[48:63], v[236:239], v[24:31], v250
    v_exp_f32 v34, v34
    v_exp_f32 v35, v35
    v_exp_f32 v36, v36
    v_mfma_f32_32x32x16_bf16 v[16:31], v[112:115], v[4:7], 0
    v_exp_f32 v37, v37
    v_exp_f32 v38, v38
    v_exp_f32 v39, v39
    v_exp_f32 v40, v40
    v_exp_f32 v41, v41
    v_smfmac_f32_32x32x32_bf16 v[64:79], v[212:215], v[32:39], v250
    v_exp_f32 v42, v42
    v_exp_f32 v43, v43
    v_exp_f32 v44, v44
    v_exp_f32 v45, v45
    v_exp_f32 v46, v46
    v_exp_f32 v47, v47
    s_setprio 0
    s_mov_b64 exec, s[62:63]
    buffer_load_dwordx4 v[232:235], v249, s[16:19], s60 offen offset:512 sc1
    s_add_u32 s59, s59, 2048
    s_and_b32 s59, s59, 0xffff
    s_add_u32 s60, s59, s58
    buffer_load_dwordx4 v[212:215], v249, s[16:19], s60 offen sc1
    s_mov_b64 exec, -1
    buffer_load_dwordx4 v[132:135], v248, s[16:19], s60 offen sc1
    s_and_b32 s49, s96, 6
    s_lshl_b32 s49, s49, 1
    s_add_u32 s49, s49, 11
    s_and_b32 s50, s49, 7
    s_bitcmp1_b32 s49, 3
    s_cselect_b32 s20, s24, s28
    s_cselect_b32 s21, s25, s29
    s_cselect_b32 s49, 81920, 0
    s_add_u32 s49, s49, s55
    s_lshl_b32 s51, s50, 10
    s_add_u32 m0, s49, s51
    s_lshl_b32 s50, s50, 13
    s_add_u32 s50, s50, s56
    buffer_load_dwordx4 v240, s[20:23], s50 offen lds
    s_mov_b64 exec, s[62:63]
    s_add_u32 s49, s57, 896
    buffer_load_dword v87, v138, s[16:19], s49 offen sc1
    s_not_b64 exec, s[62:63]
    buffer_load_dwordx4 v[80:83], v138, s[16:19], s57 offen sc1
    buffer_load_dwordx4 v[84:87], v138, s[16:19], s57 offen offset:32 sc1
    s_mov_b64 exec, -1
    s_waitcnt vmcnt(28)
    s_setprio 1
    v_exp_f32 v16, v16
    s_setprio 2
    v_exp_f32 v17, v17
    v_smfmac_f32_32x32x32_bf16 v[64:79], v[236:239], v[40:47], v250
    v_exp_f32 v18, v18
    v_exp_f32 v19, v19
    v_exp_f32 v20, v20
    v_mfma_f32_32x32x16_bf16 v[32:47], v[112:115], v[8:11], 0
    v_exp_f32 v21, v21
    v_exp_f32 v22, v22
    v_exp_f32 v23, v23
    v_exp_f32 v24, v24
    v_exp_f32 v25, v25
    v_smfmac_f32_32x32x32_bf16 v[48:63], v[192:195], v[16:23], v250
    v_exp_f32 v26, v26
    v_exp_f32 v27, v27
    v_exp_f32 v28, v28
    v_exp_f32 v29, v29
    v_exp_f32 v30, v30
    v_exp_f32 v31, v31
    v_exp_f32 v32, v32
    v_exp_f32 v33, v33
    v_smfmac_f32_32x32x32_bf16 v[48:63], v[216:219], v[24:31], v250
    v_exp_f32 v34, v34
    v_exp_f32 v35, v35
    v_exp_f32 v36, v36
    v_mfma_f32_32x32x16_bf16 v[16:31], v[116:119], v[4:7], 0
    v_exp_f32 v37, v37
    v_exp_f32 v38, v38
    v_exp_f32 v39, v39
    v_exp_f32 v40, v40
    v_exp_f32 v41, v41
    v_smfmac_f32_32x32x32_bf16 v[64:79], v[192:195], v[32:39], v250
    v_exp_f32 v42, v42
    v_exp_f32 v43, v43
    v_exp_f32 v44, v44
    v_exp_f32 v45, v45
    v_exp_f32 v46, v46
    v_exp_f32 v47, v47
    s_setprio 0
    s_mov_b64 exec, s[62:63]
    buffer_load_dwordx4 v[236:239], v249, s[16:19], s60 offen offset:512 sc1
    s_add_u32 s59, s59, 2048
    s_and_b32 s59, s59, 0xffff
    s_add_u32 s60, s59, s58
    buffer_load_dwordx4 v[192:195], v249, s[16:19], s60 offen sc1
    s_mov_b64 exec, -1
    buffer_load_dwordx4 v[112:115], v248, s[16:19], s60 offen sc1
    s_and_b32 s49, s96, 6
    s_lshl_b32 s49, s49, 1
    s_add_u32 s49, s49, 12
    s_and_b32 s50, s49, 7
    s_bitcmp1_b32 s49, 3
    s_cselect_b32 s20, s24, s28
    s_cselect_b32 s21, s25, s29
    s_cselect_b32 s49, 81920, 0
    s_add_u32 s49, s49, s55
    s_lshl_b32 s51, s50, 10
    s_add_u32 m0, s49, s51
    s_lshl_b32 s50, s50, 13
    s_add_u32 s50, s50, s56
    buffer_load_dwordx4 v240, s[20:23], s50 offen lds
    s_waitcnt vmcnt(27)
    s_setprio 1
    v_exp_f32 v16, v16
    s_setprio 2
    v_exp_f32 v17, v17
    v_smfmac_f32_32x32x32_bf16 v[64:79], v[216:219], v[40:47], v250
    v_exp_f32 v18, v18
    v_exp_f32 v19, v19
    v_exp_f32 v20, v20
    v_mfma_f32_32x32x16_bf16 v[32:47], v[116:119], v[8:11], 0
    v_exp_f32 v21, v21
    v_exp_f32 v22, v22
    v_exp_f32 v23, v23
    v_exp_f32 v24, v24
    v_exp_f32 v25, v25
    v_smfmac_f32_32x32x32_bf16 v[48:63], v[196:199], v[16:23], v250
    v_exp_f32 v26, v26
    v_exp_f32 v27, v27
    v_exp_f32 v28, v28
    v_exp_f32 v29, v29
    v_exp_f32 v30, v30
    v_exp_f32 v31, v31
    v_exp_f32 v32, v32
    v_exp_f32 v33, v33
    v_smfmac_f32_32x32x32_bf16 v[48:63], v[220:223], v[24:31], v250
    v_exp_f32 v34, v34
    v_exp_f32 v35, v35
    v_exp_f32 v36, v36
    v_mfma_f32_32x32x16_bf16 v[16:31], v[120:123], v[4:7], 0
    v_exp_f32 v37, v37
    v_exp_f32 v38, v38
    v_exp_f32 v39, v39
    v_exp_f32 v40, v40
    v_exp_f32 v41, v41
    v_smfmac_f32_32x32x32_bf16 v[64:79], v[196:199], v[32:39], v250
    v_exp_f32 v42, v42
    v_exp_f32 v43, v43
    v_exp_f32 v44, v44
    v_exp_f32 v45, v45
    v_exp_f32 v46, v46
    v_exp_f32 v47, v47
    s_setprio 3
    s_waitcnt vmcnt(4)
    v_cvt_pk_bf16_f32 v244, v80, v81
    v_cvt_pk_bf16_f32 v245, v82, v83
    v_cvt_pk_bf16_f32 v246, v84, v85
    v_cvt_pk_bf16_f32 v247, v86, v87
    s_waitcnt lgkmcnt(0)
    v_add_f32 v251, v251, v252
    v_mul_f32 v251, 0xbfb8aa3b, v251
    v_mfma_f32_32x32x16_bf16 v[176:191], v[244:247], v[12:15], 0
    v_exp_f32 v251, v251
    v_min_u32 v244, 7, v255
    v_lshrrev_b32 v245, 2, v244
    v_and_b32 v244, 3, v244
    v_lshlrev_b32 v244, 2, v244
    v_lshl_add_u32 v254, v245, 7, v244
    s_lshl_b32 s49, s96, 3
    s_lshl_b32 s50, s66, 1
    s_add_u32 s49, s49, s50
    s_lshl_b32 s49, s49, 7
    v_add_u32 v254, s49, v254
    v_add_f32 v251, 1.0, v251
    v_rcp_f32 v251, v251
    s_setprio 0
    s_mov_b64 exec, s[62:63]
    buffer_load_dwordx4 v[216:219], v249, s[16:19], s60 offen offset:512 sc1
    s_add_u32 s59, s59, 2048
    s_and_b32 s59, s59, 0xffff
    s_add_u32 s60, s59, s58
    buffer_load_dwordx4 v[196:199], v249, s[16:19], s60 offen sc1
    s_mov_b64 exec, -1
    buffer_load_dwordx4 v[116:119], v248, s[16:19], s60 offen sc1
    s_and_b32 s49, s96, 6
    s_lshl_b32 s49, s49, 1
    s_add_u32 s49, s49, 13
    s_and_b32 s50, s49, 7
    s_bitcmp1_b32 s49, 3
    s_cselect_b32 s20, s24, s28
    s_cselect_b32 s21, s25, s29
    s_cselect_b32 s49, 81920, 0
    s_add_u32 s49, s49, s55
    s_lshl_b32 s51, s50, 10
    s_add_u32 m0, s49, s51
    s_lshl_b32 s50, s50, 13
    s_add_u32 s50, s50, s56
    buffer_load_dwordx4 v240, s[20:23], s50 offen lds
    s_waitcnt vmcnt(27)
    s_setprio 1
    v_exp_f32 v16, v16
    s_setprio 2
    v_exp_f32 v17, v17
    v_smfmac_f32_32x32x32_bf16 v[64:79], v[220:223], v[40:47], v250
    v_exp_f32 v18, v18
    v_exp_f32 v19, v19
    v_exp_f32 v20, v20
    v_mfma_f32_32x32x16_bf16 v[32:47], v[120:123], v[8:11], 0
    v_exp_f32 v21, v21
    v_exp_f32 v22, v22
    v_exp_f32 v23, v23
    v_exp_f32 v24, v24
    v_exp_f32 v25, v25
    v_smfmac_f32_32x32x32_bf16 v[48:63], v[200:203], v[16:23], v250
    v_exp_f32 v26, v26
    v_exp_f32 v27, v27
    v_exp_f32 v28, v28
    v_exp_f32 v29, v29
    v_exp_f32 v30, v30
    v_exp_f32 v31, v31
    v_exp_f32 v32, v32
    v_exp_f32 v33, v33
    v_smfmac_f32_32x32x32_bf16 v[48:63], v[224:227], v[24:31], v250
    v_exp_f32 v34, v34
    v_exp_f32 v35, v35
    v_exp_f32 v36, v36
    v_mfma_f32_32x32x16_bf16 v[16:31], v[124:127], v[4:7], 0
    v_exp_f32 v37, v37
    v_exp_f32 v38, v38
    v_exp_f32 v39, v39
    v_exp_f32 v40, v40
    v_exp_f32 v41, v41
    v_smfmac_f32_32x32x32_bf16 v[64:79], v[200:203], v[32:39], v250
    v_exp_f32 v42, v42
    v_exp_f32 v43, v43
    v_exp_f32 v44, v44
    v_exp_f32 v45, v45
    v_exp_f32 v46, v46
    v_exp_f32 v47, v47
    s_setprio 3
    v_add_f32 v244, 0x358637bd, v184
    v_rcp_f32 v244, v244
    v_sub_f32 v252, 1.0, v251
    v_mul_f32 v244, v252, v244
    v_pk_mul_f32 v[176:177], v[176:177], v[244:245] op_sel_hi:[1,0]
    v_pk_mul_f32 v[178:179], v[178:179], v[244:245] op_sel_hi:[1,0]
    v_pk_mul_f32 v[180:181], v[180:181], v[244:245] op_sel_hi:[1,0]
    v_pk_mul_f32 v[182:183], v[182:183], v[244:245] op_sel_hi:[1,0]
    v_cvt_pk_bf16_f32 v188, v176, v177
    v_cvt_pk_bf16_f32 v189, v178, v179
    v_cvt_pk_bf16_f32 v190, v180, v181
    v_cvt_pk_bf16_f32 v191, v182, v183
    s_setprio 0
    s_mov_b64 exec, s[62:63]
    buffer_load_dwordx4 v[220:223], v249, s[16:19], s60 offen offset:512 sc1
    s_add_u32 s59, s59, 2048
    s_and_b32 s59, s59, 0xffff
    s_add_u32 s60, s59, s58
    buffer_load_dwordx4 v[200:203], v249, s[16:19], s60 offen sc1
    s_mov_b64 exec, -1
    buffer_load_dwordx4 v[120:123], v248, s[16:19], s60 offen sc1
    s_and_b32 s49, s96, 6
    s_lshl_b32 s49, s49, 1
    s_add_u32 s49, s49, 14
    s_and_b32 s50, s49, 7
    s_bitcmp1_b32 s49, 3
    s_cselect_b32 s20, s24, s28
    s_cselect_b32 s21, s25, s29
    s_cselect_b32 s49, 81920, 0
    s_add_u32 s49, s49, s55
    s_lshl_b32 s51, s50, 10
    s_add_u32 m0, s49, s51
    s_lshl_b32 s50, s50, 13
    s_add_u32 s50, s50, s56
    buffer_load_dwordx4 v240, s[20:23], s50 offen lds
    s_and_b32 s49, s68, 7
    s_xor_b32 s49, s49, s44
    s_lshl_b32 s49, s49, 2
    s_add_u32 s49, s49, s66
    s_lshl_b32 s49, s49, 10
    s_lshl_b32 s51, s68, 15
    s_add_u32 s51, s51, s49
    s_add_u32 s51, s51, 5242880
    buffer_store_dwordx4 v[188:191], v248, s[16:19], s51 offen sc1
    s_waitcnt vmcnt(25)
    s_setprio 1
    v_exp_f32 v16, v16
    s_setprio 2
    v_exp_f32 v17, v17
    v_smfmac_f32_32x32x32_bf16 v[64:79], v[224:227], v[40:47], v250
    v_exp_f32 v18, v18
    v_exp_f32 v19, v19
    v_exp_f32 v20, v20
    v_mfma_f32_32x32x16_bf16 v[32:47], v[124:127], v[8:11], 0
    v_exp_f32 v21, v21
    v_exp_f32 v22, v22
    v_exp_f32 v23, v23
    v_exp_f32 v24, v24
    v_exp_f32 v25, v25
    v_smfmac_f32_32x32x32_bf16 v[48:63], v[204:207], v[16:23], v250
    v_exp_f32 v26, v26
    v_exp_f32 v27, v27
    v_exp_f32 v28, v28
    v_exp_f32 v29, v29
    v_exp_f32 v30, v30
    v_exp_f32 v31, v31
    v_exp_f32 v32, v32
    v_exp_f32 v33, v33
    v_smfmac_f32_32x32x32_bf16 v[48:63], v[228:231], v[24:31], v250
    v_exp_f32 v34, v34
    v_exp_f32 v35, v35
    v_exp_f32 v36, v36
    v_mfma_f32_32x32x16_bf16 v[16:31], v[128:131], v[4:7], 0
    v_exp_f32 v37, v37
    v_exp_f32 v38, v38
    v_exp_f32 v39, v39
    v_exp_f32 v40, v40
    v_exp_f32 v41, v41
    v_smfmac_f32_32x32x32_bf16 v[64:79], v[204:207], v[32:39], v250
    v_exp_f32 v42, v42
    v_exp_f32 v43, v43
    v_exp_f32 v44, v44
    v_exp_f32 v45, v45
    v_exp_f32 v46, v46
    v_exp_f32 v47, v47
    s_setprio 0
    s_mov_b64 exec, s[62:63]
    buffer_load_dwordx4 v[224:227], v249, s[16:19], s60 offen offset:512 sc1
    s_add_u32 s59, s59, 2048
    s_and_b32 s59, s59, 0xffff
    s_add_u32 s60, s59, s58
    buffer_load_dwordx4 v[204:207], v249, s[16:19], s60 offen sc1
    s_mov_b64 exec, -1
    buffer_load_dwordx4 v[124:127], v248, s[16:19], s60 offen sc1
    s_and_b32 s49, s96, 6
    s_lshl_b32 s49, s49, 1
    s_add_u32 s49, s49, 15
    s_and_b32 s50, s49, 7
    s_bitcmp1_b32 s49, 3
    s_cselect_b32 s20, s24, s28
    s_cselect_b32 s21, s25, s29
    s_cselect_b32 s49, 81920, 0
    s_add_u32 s49, s49, s55
    s_lshl_b32 s51, s50, 10
    s_add_u32 m0, s49, s51
    s_lshl_b32 s50, s50, 13
    s_add_u32 s50, s50, s56
    buffer_load_dwordx4 v240, s[20:23], s50 offen lds
    s_waitcnt vmcnt(21)
    s_setprio 1
    v_exp_f32 v16, v16
    s_setprio 2
    v_exp_f32 v17, v17
    v_smfmac_f32_32x32x32_bf16 v[64:79], v[228:231], v[40:47], v250
    v_exp_f32 v18, v18
    v_exp_f32 v19, v19
    v_exp_f32 v20, v20
    v_mfma_f32_32x32x16_bf16 v[32:47], v[128:131], v[8:11], 0
    v_exp_f32 v21, v21
    v_exp_f32 v22, v22
    v_exp_f32 v23, v23
    v_exp_f32 v24, v24
    v_exp_f32 v25, v25
    v_smfmac_f32_32x32x32_bf16 v[48:63], v[208:211], v[16:23], v250
    v_exp_f32 v26, v26
    v_exp_f32 v27, v27
    v_exp_f32 v28, v28
    v_exp_f32 v29, v29
    v_exp_f32 v30, v30
    v_exp_f32 v31, v31
    v_exp_f32 v32, v32
    v_exp_f32 v33, v33
    v_smfmac_f32_32x32x32_bf16 v[48:63], v[232:235], v[24:31], v250
    v_exp_f32 v34, v34
    v_exp_f32 v35, v35
    v_exp_f32 v36, v36
    v_mfma_f32_32x32x16_bf16 v[16:31], v[132:135], v[4:7], 0
    v_exp_f32 v37, v37
    v_exp_f32 v38, v38
    v_exp_f32 v39, v39
    v_exp_f32 v40, v40
    v_exp_f32 v41, v41
    v_smfmac_f32_32x32x32_bf16 v[64:79], v[208:211], v[32:39], v250
    v_exp_f32 v42, v42
    v_exp_f32 v43, v43
    v_exp_f32 v44, v44
    v_exp_f32 v45, v45
    v_exp_f32 v46, v46
    v_exp_f32 v47, v47
    s_setprio 0
    s_mov_b64 exec, s[62:63]
    buffer_load_dwordx4 v[228:231], v249, s[16:19], s60 offen offset:512 sc1
    s_add_u32 s59, s59, 2048
    s_and_b32 s59, s59, 0xffff
    s_add_u32 s60, s59, s58
    buffer_load_dwordx4 v[208:211], v249, s[16:19], s60 offen sc1
    s_mov_b64 exec, -1
    buffer_load_dwordx4 v[128:131], v248, s[16:19], s60 offen sc1
    s_waitcnt vmcnt(7)
    s_lshl_b32 s49, s68, 3
    s_add_u32 s49, s49, s44
    s_lshl_b32 s49, s49, 7
    s_lshl_b32 s50, s66, 2
    s_add_u32 s49, s49, s50
    s_add_u32 s49, s49, 9568256
    s_mov_b64 exec, 1
    buffer_store_dword v136, v137, s[16:19], s49 offen sc1
    s_mov_b64 exec, -1
    s_waitcnt vmcnt(18)
    s_setprio 1
    v_exp_f32 v16, v16
    s_setprio 2
    v_exp_f32 v17, v17
    v_smfmac_f32_32x32x32_bf16 v[64:79], v[232:235], v[40:47], v250
    v_exp_f32 v18, v18
    v_exp_f32 v19, v19
    v_exp_f32 v20, v20
    v_mfma_f32_32x32x16_bf16 v[32:47], v[132:135], v[8:11], 0
    v_exp_f32 v21, v21
    v_exp_f32 v22, v22
    v_exp_f32 v23, v23
    v_exp_f32 v24, v24
    v_exp_f32 v25, v25
    v_smfmac_f32_32x32x32_bf16 v[48:63], v[212:215], v[16:23], v250
    v_exp_f32 v26, v26
    v_exp_f32 v27, v27
    v_exp_f32 v28, v28
    v_exp_f32 v29, v29
    v_exp_f32 v30, v30
    v_exp_f32 v31, v31
    v_exp_f32 v32, v32
    v_exp_f32 v33, v33
    v_smfmac_f32_32x32x32_bf16 v[48:63], v[236:239], v[24:31], v250
    v_exp_f32 v34, v34
    v_exp_f32 v35, v35
    v_exp_f32 v36, v36
    v_mfma_f32_32x32x16_bf16 v[16:31], v[112:115], v[4:7], 0
    v_exp_f32 v37, v37
    v_exp_f32 v38, v38
    v_exp_f32 v39, v39
    v_exp_f32 v40, v40
    v_exp_f32 v41, v41
    v_smfmac_f32_32x32x32_bf16 v[64:79], v[212:215], v[32:39], v250
    v_exp_f32 v42, v42
    v_exp_f32 v43, v43
    v_exp_f32 v44, v44
    v_exp_f32 v45, v45
    v_exp_f32 v46, v46
    v_exp_f32 v47, v47
    s_setprio 0
    s_mov_b64 exec, s[62:63]
    buffer_load_dwordx4 v[232:235], v249, s[16:19], s60 offen offset:512 sc1
    s_add_u32 s59, s59, 2048
    s_and_b32 s59, s59, 0xffff
    s_add_u32 s60, s59, s58
    buffer_load_dwordx4 v[212:215], v249, s[16:19], s60 offen sc1
    s_mov_b64 exec, -1
    buffer_load_dwordx4 v[132:135], v248, s[16:19], s60 offen sc1
    s_waitcnt vmcnt(17)
    s_setprio 1
    v_exp_f32 v16, v16
    s_setprio 2
    v_exp_f32 v17, v17
    v_smfmac_f32_32x32x32_bf16 v[64:79], v[236:239], v[40:47], v250
    v_exp_f32 v18, v18
    v_exp_f32 v19, v19
    v_exp_f32 v20, v20
    v_mfma_f32_32x32x16_bf16 v[32:47], v[112:115], v[8:11], 0
    v_exp_f32 v21, v21
    v_exp_f32 v22, v22
    v_exp_f32 v23, v23
    v_exp_f32 v24, v24
    v_exp_f32 v25, v25
    v_smfmac_f32_32x32x32_bf16 v[48:63], v[192:195], v[16:23], v250
    v_exp_f32 v26, v26
    v_exp_f32 v27, v27
    v_exp_f32 v28, v28
    v_exp_f32 v29, v29
    v_exp_f32 v30, v30
    v_exp_f32 v31, v31
    v_exp_f32 v32, v32
    v_exp_f32 v33, v33
    v_smfmac_f32_32x32x32_bf16 v[48:63], v[216:219], v[24:31], v250
    v_exp_f32 v34, v34
    v_exp_f32 v35, v35
    v_exp_f32 v36, v36
    v_mfma_f32_32x32x16_bf16 v[16:31], v[116:119], v[4:7], 0
    v_exp_f32 v37, v37
    v_exp_f32 v38, v38
    v_exp_f32 v39, v39
    v_exp_f32 v40, v40
    v_exp_f32 v41, v41
    v_smfmac_f32_32x32x32_bf16 v[64:79], v[192:195], v[32:39], v250
    v_exp_f32 v42, v42
    v_exp_f32 v43, v43
    v_exp_f32 v44, v44
    v_exp_f32 v45, v45
    v_exp_f32 v46, v46
    v_exp_f32 v47, v47
    s_setprio 0
    s_mov_b64 exec, s[62:63]
    buffer_load_dwordx4 v[236:239], v249, s[16:19], s60 offen offset:512 sc1
    s_add_u32 s59, s59, 2048
    s_and_b32 s59, s59, 0xffff
    s_add_u32 s60, s59, s58
    buffer_load_dwordx4 v[192:195], v249, s[16:19], s60 offen sc1
    s_mov_b64 exec, -1
    buffer_load_dwordx4 v[112:115], v248, s[16:19], s60 offen sc1
    s_waitcnt vmcnt(16)
    s_setprio 1
    v_exp_f32 v16, v16
    s_setprio 2
    v_exp_f32 v17, v17
    v_smfmac_f32_32x32x32_bf16 v[64:79], v[216:219], v[40:47], v250
    v_exp_f32 v18, v18
    v_exp_f32 v19, v19
    v_exp_f32 v20, v20
    v_mfma_f32_32x32x16_bf16 v[32:47], v[116:119], v[8:11], 0
    v_exp_f32 v21, v21
    v_exp_f32 v22, v22
    v_exp_f32 v23, v23
    v_exp_f32 v24, v24
    v_exp_f32 v25, v25
    v_smfmac_f32_32x32x32_bf16 v[48:63], v[196:199], v[16:23], v250
    v_exp_f32 v26, v26
    v_exp_f32 v27, v27
    v_exp_f32 v28, v28
    v_exp_f32 v29, v29
    v_exp_f32 v30, v30
    v_exp_f32 v31, v31
    v_exp_f32 v32, v32
    v_exp_f32 v33, v33
    v_smfmac_f32_32x32x32_bf16 v[48:63], v[220:223], v[24:31], v250
    v_exp_f32 v34, v34
    v_exp_f32 v35, v35
    v_exp_f32 v36, v36
    v_mfma_f32_32x32x16_bf16 v[16:31], v[120:123], v[4:7], 0
    v_exp_f32 v37, v37
    v_exp_f32 v38, v38
    v_exp_f32 v39, v39
    v_exp_f32 v40, v40
    v_exp_f32 v41, v41
    v_smfmac_f32_32x32x32_bf16 v[64:79], v[196:199], v[32:39], v250
    v_exp_f32 v42, v42
    v_exp_f32 v43, v43
    v_exp_f32 v44, v44
    v_exp_f32 v45, v45
    v_exp_f32 v46, v46
    v_exp_f32 v47, v47
    s_setprio 0
    s_mov_b64 exec, s[62:63]
    buffer_load_dwordx4 v[216:219], v249, s[16:19], s60 offen offset:512 sc1
    s_add_u32 s59, s59, 2048
    s_and_b32 s59, s59, 0xffff
    s_add_u32 s60, s59, s58
    buffer_load_dwordx4 v[196:199], v249, s[16:19], s60 offen sc1
    s_mov_b64 exec, -1
    buffer_load_dwordx4 v[116:119], v248, s[16:19], s60 offen sc1
    s_mov_b32 s57, 9568256
    buffer_load_dword v253, v254, s[16:19], s57 offen sc1
    s_lshl_b32 s49, s66, 1
    s_add_u32 s49, s49, 0
    s_and_b32 s50, s96, 7
    s_xor_b32 s49, s49, s50
    s_lshl_b32 s49, s49, 12
    s_lshl_b32 s50, s96, 15
    s_add_u32 s49, s49, s50
    s_add_u32 s53, s49, 5242880
    s_lshl_b32 s49, s66, 1
    s_add_u32 s49, s49, 1
    s_and_b32 s50, s96, 7
    s_xor_b32 s49, s49, s50
    s_lshl_b32 s49, s49, 12
    s_lshl_b32 s50, s96, 15
    s_add_u32 s49, s49, s50
    s_add_u32 s54, s49, 5242880
    s_waitcnt vmcnt(15)
    s_setprio 1
    v_exp_f32 v16, v16
    s_setprio 2
    v_exp_f32 v17, v17
    v_smfmac_f32_32x32x32_bf16 v[64:79], v[220:223], v[40:47], v250
    v_exp_f32 v18, v18
    v_exp_f32 v19, v19
    v_exp_f32 v20, v20
    v_mfma_f32_32x32x16_bf16 v[32:47], v[120:123], v[8:11], 0
    v_exp_f32 v21, v21
    v_exp_f32 v22, v22
    v_exp_f32 v23, v23
    v_exp_f32 v24, v24
    v_exp_f32 v25, v25
    v_smfmac_f32_32x32x32_bf16 v[48:63], v[200:203], v[16:23], v250
    v_exp_f32 v26, v26
    v_exp_f32 v27, v27
    v_exp_f32 v28, v28
    v_exp_f32 v29, v29
    v_exp_f32 v30, v30
    v_exp_f32 v31, v31
    v_exp_f32 v32, v32
    v_exp_f32 v33, v33
    v_smfmac_f32_32x32x32_bf16 v[48:63], v[224:227], v[24:31], v250
    v_exp_f32 v34, v34
    v_exp_f32 v35, v35
    v_exp_f32 v36, v36
    v_mfma_f32_32x32x16_bf16 v[16:31], v[124:127], v[4:7], 0
    v_exp_f32 v37, v37
    v_exp_f32 v38, v38
    v_exp_f32 v39, v39
    v_exp_f32 v40, v40
    v_exp_f32 v41, v41
    v_smfmac_f32_32x32x32_bf16 v[64:79], v[200:203], v[32:39], v250
    v_exp_f32 v42, v42
    v_exp_f32 v43, v43
    v_exp_f32 v44, v44
    v_exp_f32 v45, v45
    v_exp_f32 v46, v46
    v_exp_f32 v47, v47
    s_setprio 0
    s_mov_b64 exec, s[62:63]
    buffer_load_dwordx4 v[220:223], v249, s[16:19], s60 offen offset:512 sc1
    s_mov_b64 exec, -1
    s_waitcnt vmcnt(12)
    s_setprio 1
    v_exp_f32 v16, v16
    s_setprio 2
    v_exp_f32 v17, v17
    v_smfmac_f32_32x32x32_bf16 v[64:79], v[224:227], v[40:47], v250
    v_exp_f32 v18, v18
    v_exp_f32 v19, v19
    v_exp_f32 v20, v20
    v_mfma_f32_32x32x16_bf16 v[32:47], v[124:127], v[8:11], 0
    v_exp_f32 v21, v21
    v_exp_f32 v22, v22
    v_exp_f32 v23, v23
    v_exp_f32 v24, v24
    v_exp_f32 v25, v25
    v_smfmac_f32_32x32x32_bf16 v[48:63], v[204:207], v[16:23], v250
    v_exp_f32 v26, v26
    v_exp_f32 v27, v27
    v_exp_f32 v28, v28
    v_exp_f32 v29, v29
    v_exp_f32 v30, v30
    v_exp_f32 v31, v31
    v_exp_f32 v32, v32
    v_exp_f32 v33, v33
    v_smfmac_f32_32x32x32_bf16 v[48:63], v[228:231], v[24:31], v250
    v_exp_f32 v34, v34
    v_exp_f32 v35, v35
    v_exp_f32 v36, v36
    v_mfma_f32_32x32x16_bf16 v[16:31], v[128:131], v[4:7], 0
    v_exp_f32 v37, v37
    v_exp_f32 v38, v38
    v_exp_f32 v39, v39
    v_exp_f32 v40, v40
    v_exp_f32 v41, v41
    v_smfmac_f32_32x32x32_bf16 v[64:79], v[204:207], v[32:39], v250
    v_exp_f32 v42, v42
    v_exp_f32 v43, v43
    v_exp_f32 v44, v44
    v_exp_f32 v45, v45
    v_exp_f32 v46, v46
    v_exp_f32 v47, v47
    s_setprio 3
    s_waitcnt vmcnt(1)
    s_mov_b32 s65, 100000
L_fob_36:
    v_cmp_ne_u32 vcc, s48, v253
    s_sub_u32 s65, s65, 1
    s_cbranch_vccz L_fobok_37
    s_cbranch_scc1 L_fobok_37
    buffer_load_dword v253, v254, s[16:19], s57 offen sc1
    s_waitcnt vmcnt(0)
    s_branch L_fob_36
L_fobok_37:
    s_setprio 0
    buffer_load_dwordx4 v[144:147], v248, s[16:19], s53 offen offset:0 sc1
    buffer_load_dwordx4 v[148:151], v248, s[16:19], s53 offen offset:1024 sc1
    buffer_load_dwordx4 v[152:155], v248, s[16:19], s53 offen offset:2048 sc1
    s_waitcnt vmcnt(11)
    s_setprio 1
    v_exp_f32 v16, v16
    s_setprio 2
    v_exp_f32 v17, v17
    v_smfmac_f32_32x32x32_bf16 v[64:79], v[228:231], v[40:47], v250
    v_exp_f32 v18, v18
    v_exp_f32 v19, v19
    v_exp_f32 v20, v20
    v_mfma_f32_32x32x16_bf16 v[32:47], v[128:131], v[8:11], 0
    v_exp_f32 v21, v21
    v_exp_f32 v22, v22
    v_exp_f32 v23, v23
    v_exp_f32 v24, v24
    v_exp_f32 v25, v25
    v_smfmac_f32_32x32x32_bf16 v[48:63], v[208:211], v[16:23], v250
    v_exp_f32 v26, v26
    v_exp_f32 v27, v27
    v_exp_f32 v28, v28
    v_exp_f32 v29, v29
    v_exp_f32 v30, v30
    v_exp_f32 v31, v31
    v_exp_f32 v32, v32
    v_exp_f32 v33, v33
    v_smfmac_f32_32x32x32_bf16 v[48:63], v[232:235], v[24:31], v250
    v_exp_f32 v34, v34
    v_exp_f32 v35, v35
    v_exp_f32 v36, v36
    v_mfma_f32_32x32x16_bf16 v[16:31], v[132:135], v[4:7], 0
    v_exp_f32 v37, v37
    v_exp_f32 v38, v38
    v_exp_f32 v39, v39
    v_exp_f32 v40, v40
    v_exp_f32 v41, v41
    v_smfmac_f32_32x32x32_bf16 v[64:79], v[208:211], v[32:39], v250
    v_exp_f32 v42, v42
    v_exp_f32 v43, v43
    v_exp_f32 v44, v44
    v_exp_f32 v45, v45
    v_exp_f32 v46, v46
    v_exp_f32 v47, v47
    s_setprio 0
    buffer_load_dwordx4 v[156:159], v248, s[16:19], s53 offen offset:3072 sc1
    buffer_load_dwordx4 v[160:163], v248, s[16:19], s54 offen offset:0 sc1
    buffer_load_dwordx4 v[164:167], v248, s[16:19], s54 offen offset:1024 sc1
    s_waitcnt vmcnt(11)
    s_setprio 1
    v_exp_f32 v16, v16
    s_setprio 2
    v_exp_f32 v17, v17
    v_smfmac_f32_32x32x32_bf16 v[64:79], v[232:235], v[40:47], v250
    v_exp_f32 v18, v18
    v_exp_f32 v19, v19
    v_exp_f32 v20, v20
    v_mfma_f32_32x32x16_bf16 v[32:47], v[132:135], v[8:11], 0
    v_exp_f32 v21, v21
    v_exp_f32 v22, v22
    v_exp_f32 v23, v23
    v_exp_f32 v24, v24
    v_exp_f32 v25, v25
    v_smfmac_f32_32x32x32_bf16 v[48:63], v[212:215], v[16:23], v250
    v_exp_f32 v26, v26
    v_exp_f32 v27, v27
    v_exp_f32 v28, v28
    v_exp_f32 v29, v29
    v_exp_f32 v30, v30
    v_exp_f32 v31, v31
    v_exp_f32 v32, v32
    v_exp_f32 v33, v33
    v_smfmac_f32_32x32x32_bf16 v[48:63], v[236:239], v[24:31], v250
    v_exp_f32 v34, v34
    v_exp_f32 v35, v35
    v_exp_f32 v36, v36
    v_mfma_f32_32x32x16_bf16 v[16:31], v[112:115], v[4:7], 0
    v_exp_f32 v37, v37
    v_exp_f32 v38, v38
    v_exp_f32 v39, v39
    v_exp_f32 v40, v40
    v_exp_f32 v41, v41
    v_smfmac_f32_32x32x32_bf16 v[64:79], v[212:215], v[32:39], v250
    v_exp_f32 v42, v42
    v_exp_f32 v43, v43
    v_exp_f32 v44, v44
    v_exp_f32 v45, v45
    v_exp_f32 v46, v46
    v_exp_f32 v47, v47
    s_setprio 0
    buffer_load_dwordx4 v[168:171], v248, s[16:19], s54 offen offset:2048 sc1
    buffer_load_dwordx4 v[172:175], v248, s[16:19], s54 offen offset:3072 sc1
    s_waitcnt vmcnt(10)
    s_setprio 1
    v_exp_f32 v16, v16
    s_setprio 2
    v_exp_f32 v17, v17
    v_smfmac_f32_32x32x32_bf16 v[64:79], v[236:239], v[40:47], v250
    v_exp_f32 v18, v18
    v_exp_f32 v19, v19
    v_exp_f32 v20, v20
    v_mfma_f32_32x32x16_bf16 v[32:47], v[112:115], v[8:11], 0
    v_exp_f32 v21, v21
    v_exp_f32 v22, v22
    v_exp_f32 v23, v23
    v_exp_f32 v24, v24
    v_exp_f32 v25, v25
    v_smfmac_f32_32x32x32_bf16 v[48:63], v[192:195], v[16:23], v250
    v_exp_f32 v26, v26
    v_exp_f32 v27, v27
    v_exp_f32 v28, v28
    v_exp_f32 v29, v29
    v_exp_f32 v30, v30
    v_exp_f32 v31, v31
    v_exp_f32 v32, v32
    v_exp_f32 v33, v33
    v_smfmac_f32_32x32x32_bf16 v[48:63], v[216:219], v[24:31], v250
    v_exp_f32 v34, v34
    v_exp_f32 v35, v35
    v_exp_f32 v36, v36
    v_mfma_f32_32x32x16_bf16 v[16:31], v[116:119], v[4:7], 0
    v_exp_f32 v37, v37
    v_exp_f32 v38, v38
    v_exp_f32 v39, v39
    v_exp_f32 v40, v40
    v_exp_f32 v41, v41
    v_smfmac_f32_32x32x32_bf16 v[64:79], v[192:195], v[32:39], v250
    v_exp_f32 v42, v42
    v_exp_f32 v43, v43
    v_exp_f32 v44, v44
    v_exp_f32 v45, v45
    v_exp_f32 v46, v46
    v_exp_f32 v47, v47
    s_setprio 0
    s_waitcnt vmcnt(8)
    s_setprio 1
    v_exp_f32 v16, v16
    s_setprio 2
    v_exp_f32 v17, v17
    v_smfmac_f32_32x32x32_bf16 v[64:79], v[216:219], v[40:47], v250
    v_exp_f32 v18, v18
    v_exp_f32 v19, v19
    v_exp_f32 v20, v20
    v_mfma_f32_32x32x16_bf16 v[32:47], v[116:119], v[8:11], 0
    v_exp_f32 v21, v21
    v_exp_f32 v22, v22
    v_exp_f32 v23, v23
    v_exp_f32 v24, v24
    v_exp_f32 v25, v25
    v_smfmac_f32_32x32x32_bf16 v[48:63], v[196:199], v[16:23], v250
    v_exp_f32 v26, v26
    v_exp_f32 v27, v27
    v_exp_f32 v28, v28
    v_exp_f32 v29, v29
    v_exp_f32 v30, v30
    v_exp_f32 v31, v31
    v_exp_f32 v32, v32
    v_exp_f32 v33, v33
    v_smfmac_f32_32x32x32_bf16 v[48:63], v[220:223], v[24:31], v250
    v_exp_f32 v34, v34
    v_exp_f32 v35, v35
    v_exp_f32 v36, v36
    v_mfma_f32_32x32x16_bf16 v[16:31], v[120:123], v[4:7], 0
    v_exp_f32 v37, v37
    v_exp_f32 v38, v38
    v_exp_f32 v39, v39
    v_exp_f32 v40, v40
    v_exp_f32 v41, v41
    v_smfmac_f32_32x32x32_bf16 v[64:79], v[196:199], v[32:39], v250
    v_exp_f32 v42, v42
    v_exp_f32 v43, v43
    v_exp_f32 v44, v44
    v_exp_f32 v45, v45
    v_exp_f32 v46, v46
    v_exp_f32 v47, v47
    s_setprio 0
    s_waitcnt vmcnt(0)
    s_xor_b32 s49, s47, 4
    s_lshl_b32 s50, s49, 11
    s_add_u32 s50, s50, 65536
    v_add_u32 v1, s50, v248
    s_lshl_b32 s50, s49, 8
    s_add_u32 s50, s50, 149504
    v_smfmac_f32_32x32x32_bf16 v[64:79], v[220:223], v[40:47], v250
    v_lshl_add_u32 v2, v255, 2, s50
    ds_write_b128 v1, v[48:51]
    ds_write_b128 v1, v[52:55] offset:1024
    ds_write_b32 v2, v56
L_attn_done:
    v_xor_b32 v3, 8192, v1
    v_xor_b32 v246, 1024, v2
    v_mov_b32 v247, 148996
    s_mov_b32 s51, 0x4e800000
    s_mov_b32 s52, 0x30800000
    v_bfe_u32 v1, v255, 2, 2
    v_lshrrev_b32 v2, 5, v255
    v_lshl_add_u32 v1, v2, 2, v1
    v_lshlrev_b32 v240, 7, v1
    v_bfe_u32 v1, v255, 3, 1
    s_lshr_b32 s49, s66, 1
    v_xor_b32 v1, s49, v1
    v_bfe_u32 v2, v255, 4, 1
    s_and_b32 s50, s66, 1
    v_xor_b32 v2, s50, v2
    v_lshl_add_u32 v1, v1, 1, v2
    v_lshlrev_b32 v1, 5, v1
    v_and_b32 v2, 3, v255
    v_lshl_add_u32 v1, v2, 3, v1
    v_add_u32 v240, v240, v1
    s_lshl_b32 s49, s66, 14
    v_add_u32 v240, s49, v240
    v_xor_b32 v241, 64, v240
    v_add_u32 v242, 81920, v240
    v_add_u32 v243, 81920, v241
    v_min_f32 v245, v56, v72
    v_add_f32 v244, v56, v72
    v_cmp_nle_f32 vcc, v244, s51
    v_cmp_nge_f32 s[78:79], v245, s52
    s_or_b64 vcc, vcc, s[78:79]
    s_cbranch_vccz L_ok_38
    v_mov_b32 v245, 1
    ds_write_b32 v247, v245
L_ok_38:
    s_waitcnt lgkmcnt(0)
    s_barrier
    ds_read_b32 v247, v247
    ds_read_b32 v244, v246
    ds_read_b128 v[16:19], v3
    ds_read_b128 v[20:23], v3 offset:1024
    ds_read_b64_tr_b16 v[176:177], v240 offset:0
    ds_read_b64_tr_b16 v[178:179], v240 offset:1024
    ds_read_b64_tr_b16 v[180:181], v241 offset:0
    ds_read_b64_tr_b16 v[182:183], v241 offset:1024
    ds_read_b64_tr_b16 v[184:185], v240 offset:2048
    ds_read_b64_tr_b16 v[186:187], v240 offset:3072
    ds_read_b64_tr_b16 v[188:189], v241 offset:2048
    ds_read_b64_tr_b16 v[190:191], v241 offset:3072
    s_and_b32 s49, s68, 7
    s_xor_b32 s49, s49, s44
    s_lshl_b32 s49, s49, 2
    s_add_u32 s49, s49, s66
    s_lshl_b32 s49, s49, 10
    s_lshl_b32 s51, s68, 15
    s_add_u32 s51, s51, s49
    s_add_u32 s51, s51, 7340032
    s_waitcnt lgkmcnt(10)
    v_readfirstlane_b32 s52, v247
    v_add_f32 v244, v244, v72
    v_rcp_f32 v244, v244
    s_cmp_gt_u32 s52, s64
    s_cbranch_scc1 L_fallback
    v_mul_f32 v244, v251, v244
    s_waitcnt lgkmcnt(8)
    v_pk_add_f32 v[16:17], v[16:17], v[64:65]
    v_pk_add_f32 v[18:19], v[18:19], v[66:67]
    v_pk_add_f32 v[20:21], v[20:21], v[68:69]
    v_pk_add_f32 v[22:23], v[22:23], v[70:71]
    v_pk_mul_f32 v[16:17], v[16:17], v[244:245] op_sel_hi:[1,0]
    v_pk_mul_f32 v[18:19], v[18:19], v[244:245] op_sel_hi:[1,0]
    v_pk_mul_f32 v[20:21], v[20:21], v[244:245] op_sel_hi:[1,0]
    v_pk_mul_f32 v[22:23], v[22:23], v[244:245] op_sel_hi:[1,0]
    v_cvt_pk_bf16_f32 v12, v16, v17
    v_cvt_pk_bf16_f32 v13, v18, v19
    v_cvt_pk_bf16_f32 v14, v20, v21
    v_cvt_pk_bf16_f32 v15, v22, v23
    v_min_u32 v12, -2, v12
    v_min_u32 v13, -2, v13
    v_min_u32 v14, -2, v14
    v_min_u32 v15, -2, v15
    buffer_store_dwordx4 v[12:15], v248, s[16:19], s51 offen sc1
    s_lshl_b32 s49, s66, 1
    s_add_u32 s49, s49, 0
    s_and_b32 s50, s96, 7
    s_xor_b32 s49, s49, s50
    s_lshl_b32 s49, s49, 12
    s_lshl_b32 s50, s96, 15
    s_add_u32 s49, s49, s50
    s_add_u32 s53, s49, 7340032
    s_lshl_b32 s49, s66, 1
    s_add_u32 s49, s49, 1
    s_and_b32 s50, s96, 7
    s_xor_b32 s49, s49, s50
    s_lshl_b32 s49, s49, 12
    s_lshl_b32 s50, s96, 15
    s_add_u32 s49, s49, s50
    s_add_u32 s54, s49, 7340032
    ds_read_b64_tr_b16 v[192:193], v240 offset:4096
    ds_read_b64_tr_b16 v[194:195], v240 offset:5120
    ds_read_b64_tr_b16 v[196:197], v241 offset:4096
    ds_read_b64_tr_b16 v[198:199], v241 offset:5120
    s_waitcnt lgkmcnt(8)
    v_mfma_f32_32x32x16_bf16 v[112:127], v[176:179], v[144:147], 0
    ds_read_b64_tr_b16 v[200:201], v240 offset:6144
    ds_read_b64_tr_b16 v[202:203], v240 offset:7168
    ds_read_b64_tr_b16 v[204:205], v241 offset:6144
    ds_read_b64_tr_b16 v[206:207], v241 offset:7168
    v_mfma_f32_32x32x16_bf16 v[128:143], v[180:183], v[144:147], 0
    ds_read_b64_tr_b16 v[208:209], v240 offset:8192
    ds_read_b64_tr_b16 v[210:211], v240 offset:9216
    ds_read_b64_tr_b16 v[212:213], v241 offset:8192
    ds_read_b64_tr_b16 v[214:215], v241 offset:9216
    s_waitcnt lgkmcnt(12)
    v_mfma_f32_32x32x16_bf16 v[112:127], v[184:187], v[148:151], v[112:127]
    ds_read_b64_tr_b16 v[216:217], v240 offset:10240
    ds_read_b64_tr_b16 v[218:219], v240 offset:11264
    ds_read_b64_tr_b16 v[220:221], v241 offset:10240
    ds_read_b64_tr_b16 v[222:223], v241 offset:11264
    v_mfma_f32_32x32x16_bf16 v[128:143], v[188:191], v[148:151], v[128:143]
    ds_read_b64_tr_b16 v[224:225], v240 offset:12288
    ds_read_b64_tr_b16 v[226:227], v240 offset:13312
    ds_read_b64_tr_b16 v[228:229], v241 offset:12288
    ds_read_b64_tr_b16 v[230:231], v241 offset:13312
    s_waitcnt lgkmcnt(15)
    v_mfma_f32_32x32x16_bf16 v[112:127], v[192:195], v[152:155], v[112:127]
    ds_read_b64_tr_b16 v[232:233], v240 offset:14336
    ds_read_b64_tr_b16 v[234:235], v240 offset:15360
    ds_read_b64_tr_b16 v[236:237], v241 offset:14336
    ds_read_b64_tr_b16 v[238:239], v241 offset:15360
    v_mfma_f32_32x32x16_bf16 v[128:143], v[196:199], v[152:155], v[128:143]
    ds_read_b64_tr_b16 v[48:49], v242 offset:0
    ds_read_b64_tr_b16 v[50:51], v242 offset:1024
    ds_read_b64_tr_b16 v[52:53], v243 offset:0
    s_waitcnt lgkmcnt(15)
    v_mfma_f32_32x32x16_bf16 v[112:127], v[200:203], v[156:159], v[112:127]
    ds_read_b64_tr_b16 v[54:55], v243 offset:1024
    ds_read_b64_tr_b16 v[56:57], v242 offset:2048
    ds_read_b64_tr_b16 v[58:59], v242 offset:3072
    v_mfma_f32_32x32x16_bf16 v[128:143], v[204:207], v[156:159], v[128:143]
    ds_read_b64_tr_b16 v[60:61], v243 offset:2048
    ds_read_b64_tr_b16 v[62:63], v243 offset:3072
    ds_read_b64_tr_b16 v[64:65], v242 offset:4096
    s_waitcnt lgkmcnt(15)
    v_mfma_f32_32x32x16_bf16 v[112:127], v[208:211], v[160:163], v[112:127]
    ds_read_b64_tr_b16 v[66:67], v242 offset:5120
    ds_read_b64_tr_b16 v[68:69], v243 offset:4096
    ds_read_b64_tr_b16 v[70:71], v243 offset:5120
    v_mfma_f32_32x32x16_bf16 v[128:143], v[212:215], v[160:163], v[128:143]
    ds_read_b64_tr_b16 v[72:73], v242 offset:6144
    ds_read_b64_tr_b16 v[74:75], v242 offset:7168
    ds_read_b64_tr_b16 v[76:77], v243 offset:6144
    s_waitcnt lgkmcnt(15)
    v_mfma_f32_32x32x16_bf16 v[112:127], v[216:219], v[164:167], v[112:127]
    ds_read_b64_tr_b16 v[78:79], v243 offset:7168
    ds_read_b64_tr_b16 v[80:81], v242 offset:8192
    ds_read_b64_tr_b16 v[82:83], v242 offset:9216
    v_mfma_f32_32x32x16_bf16 v[128:143], v[220:223], v[164:167], v[128:143]
    ds_read_b64_tr_b16 v[84:85], v243 offset:8192
    ds_read_b64_tr_b16 v[86:87], v243 offset:9216
    ds_read_b64_tr_b16 v[88:89], v242 offset:10240
    s_waitcnt lgkmcnt(15)
    v_mfma_f32_32x32x16_bf16 v[112:127], v[224:227], v[168:171], v[112:127]
    ds_read_b64_tr_b16 v[90:91], v242 offset:11264
    ds_read_b64_tr_b16 v[92:93], v243 offset:10240
    ds_read_b64_tr_b16 v[94:95], v243 offset:11264
    v_mfma_f32_32x32x16_bf16 v[128:143], v[228:231], v[168:171], v[128:143]
    ds_read_b64_tr_b16 v[96:97], v242 offset:12288
    ds_read_b64_tr_b16 v[98:99], v242 offset:13312
    ds_read_b64_tr_b16 v[100:101], v243 offset:12288
    s_waitcnt lgkmcnt(15)
    v_mov_b32 v1, 149008
    v_mov_b32 v2, 1
    s_mov_b64 exec, 1
    ds_add_u32 v1, v2
    s_mov_b64 exec, -1
    v_mfma_f32_32x32x16_bf16 v[112:127], v[232:235], v[172:175], v[112:127]
    ds_read_b64_tr_b16 v[102:103], v243 offset:13312
    ds_read_b64_tr_b16 v[104:105], v242 offset:14336
    ds_read_b64_tr_b16 v[106:107], v242 offset:15360
    v_mfma_f32_32x32x16_bf16 v[128:143], v[236:239], v[172:175], v[128:143]
    buffer_load_dwordx4 v[16:19], v248, s[16:19], s53 offen offset:0 sc1
    buffer_load_dwordx4 v[20:23], v248, s[16:19], s53 offen offset:1024 sc1
    buffer_load_dwordx4 v[24:27], v248, s[16:19], s53 offen offset:2048 sc1
    buffer_load_dwordx4 v[28:31], v248, s[16:19], s53 offen offset:3072 sc1
    buffer_load_dwordx4 v[32:35], v248, s[16:19], s54 offen offset:0 sc1
    buffer_load_dwordx4 v[36:39], v248, s[16:19], s54 offen offset:1024 sc1
    buffer_load_dwordx4 v[40:43], v248, s[16:19], s54 offen offset:2048 sc1
    buffer_load_dwordx4 v[44:47], v248, s[16:19], s54 offen offset:3072 sc1
    ds_read_b64_tr_b16 v[108:109], v243 offset:14336
    ds_read_b64_tr_b16 v[110:111], v243 offset:15360
    s_xor_b32 s49, s47, 1
    s_mul_i32 s49, s49, 6144
    s_add_u32 s49, s49, 0
    v_add_u32 v13, s49, v248
    s_xor_b32 s49, s47, 2
    s_mul_i32 s49, s49, 6144
    s_add_u32 s49, s49, 2048
    v_add_u32 v14, s49, v248
    s_xor_b32 s49, s47, 3
    s_mul_i32 s49, s49, 6144
    s_add_u32 s49, s49, 4096
    v_add_u32 v15, s49, v248
    s_mul_i32 s49, s47, 6144
    s_add_u32 s49, s49, 0
    v_add_u32 v12, s49, v248
    v_and_b32 v1, 31, v255
    v_lshlrev_b32 v1, 10, v1
    v_lshrrev_b32 v2, 5, v255
    v_lshl_add_u32 v1, v2, 4, v1
    s_lshl_b32 s51, s96, 15
    s_lshl_b32 s49, s97, 7
    s_add_u32 s51, s51, s49
    s_lshl_b32 s49, s66, 5
    s_add_u32 s51, s51, s49
    v_add_u32 v253, s51, v1
    s_mov_b32 s65, 100000
    v_mov_b32 v1, 149008
    s_waitcnt vmcnt(7)
    v_max3_u32 v3, v16, v17, v18
    v_max_u32 v3, v3, v19
    v_cmp_eq_u32 vcc, -1, v3
    s_cbranch_vccnz L_oa_alt
    s_waitcnt vmcnt(7)
L_oa_chk0_0:
    v_max3_u32 v3, v16, v17, v18
    v_max_u32 v3, v3, v19
    v_cmp_eq_u32 vcc, -1, v3
    s_cbranch_vccnz L_oa_retry0_0
L_oa_go0_0:
    s_waitcnt lgkmcnt(15)
    v_mfma_f32_32x32x16_bf16 v[128:143], v[52:55], v[16:19], v[128:143]
    v_mfma_f32_32x32x16_bf16 v[112:127], v[48:51], v[16:19], v[112:127]
    s_waitcnt vmcnt(6)
L_oa_chk0_1:
    v_max3_u32 v3, v20, v21, v22
    v_max_u32 v3, v3, v23
    v_cmp_eq_u32 vcc, -1, v3
    s_cbranch_vccnz L_oa_retry0_1
L_oa_go0_1:
    s_waitcnt lgkmcnt(15)
    v_mfma_f32_32x32x16_bf16 v[128:143], v[60:63], v[20:23], v[128:143]
    v_mfma_f32_32x32x16_bf16 v[112:127], v[56:59], v[20:23], v[112:127]
    s_waitcnt vmcnt(5)
L_oa_chk0_2:
    v_max3_u32 v3, v24, v25, v26
    v_max_u32 v3, v3, v27
    v_cmp_eq_u32 vcc, -1, v3
    s_cbranch_vccnz L_oa_retry0_2
L_oa_go0_2:
    s_waitcnt lgkmcnt(15)
    v_mfma_f32_32x32x16_bf16 v[128:143], v[68:71], v[24:27], v[128:143]
    v_mfma_f32_32x32x16_bf16 v[112:127], v[64:67], v[24:27], v[112:127]
    s_waitcnt vmcnt(4)
L_oa_chk0_3:
    v_max3_u32 v3, v28, v29, v30
    v_max_u32 v3, v3, v31
    v_cmp_eq_u32 vcc, -1, v3
    s_cbranch_vccnz L_oa_retry0_3
L_oa_go0_3:
    s_waitcnt lgkmcnt(15)
    v_mfma_f32_32x32x16_bf16 v[128:143], v[76:79], v[28:31], v[128:143]
    v_mfma_f32_32x32x16_bf16 v[112:127], v[72:75], v[28:31], v[112:127]
    s_waitcnt vmcnt(3)
L_oa_chk0_4:
    v_max3_u32 v3, v32, v33, v34
    v_max_u32 v3, v3, v35
    v_cmp_eq_u32 vcc, -1, v3
    s_cbranch_vccnz L_oa_retry0_4
L_oa_go0_4:
    s_waitcnt lgkmcnt(13)
    v_mfma_f32_32x32x16_bf16 v[128:143], v[84:87], v[32:35], v[128:143]
    ds_read_b32 v2, v1
    v_mfma_f32_32x32x16_bf16 v[112:127], v[80:83], v[32:35], v[112:127]
    s_waitcnt vmcnt(2)
L_oa_chk0_5:
    v_max3_u32 v3, v36, v37, v38
    v_max_u32 v3, v3, v39
    v_cmp_eq_u32 vcc, -1, v3
    s_cbranch_vccnz L_oa_retry0_5
L_oa_go0_5:
    s_waitcnt lgkmcnt(9)
    v_mfma_f32_32x32x16_bf16 v[128:143], v[92:95], v[36:39], v[128:143]
    s_waitcnt vmcnt(1)
L_oa_chk0_6:
    v_max3_u32 v3, v40, v41, v42
    v_max_u32 v3, v3, v43
    v_cmp_eq_u32 vcc, -1, v3
    s_cbranch_vccnz L_oa_retry0_6
L_oa_go0_6:
    s_waitcnt lgkmcnt(4)
    v_mfma_f32_32x32x16_bf16 v[128:143], v[100:103], v[40:43], v[128:143]
    s_waitcnt vmcnt(0)
L_oa_chk0_7:
    v_max3_u32 v3, v44, v45, v46
    v_max_u32 v3, v3, v47
    v_cmp_eq_u32 vcc, -1, v3
    s_cbranch_vccnz L_oa_retry0_7
L_oa_go0_7:
    s_waitcnt lgkmcnt(0)
    v_mfma_f32_32x32x16_bf16 v[128:143], v[108:111], v[44:47], v[128:143]
    v_mfma_f32_32x32x16_bf16 v[112:127], v[88:91], v[36:39], v[112:127]
    s_mov_b32 s65, 100000
L_wb_39:
    s_waitcnt lgkmcnt(0)
    v_readfirstlane_b32 s49, v2
    s_sub_u32 s65, s65, 1
    s_cbranch_scc1 L_wbok_40
    s_cmp_eq_u32 s49, 8
    s_cbranch_scc1 L_wbok_40
    ds_read_b32 v2, v1
    s_branch L_wb_39
L_wbok_40:
    s_nop 3
    ds_write_b128 v14, v[128:131] offset:0
    ds_write_b128 v14, v[132:135] offset:1024
    v_mfma_f32_32x32x16_bf16 v[112:127], v[96:99], v[40:43], v[112:127]
    ds_write_b128 v15, v[136:139] offset:0
    ds_write_b128 v15, v[140:143] offset:1024
    v_mfma_f32_32x32x16_bf16 v[112:127], v[104:107], v[44:47], v[112:127]
L_oa_join:
    s_nop 11
    ds_write_b128 v13, v[120:123] offset:0
    ds_write_b128 v13, v[124:127] offset:1024
    s_waitcnt lgkmcnt(0)
    s_barrier
    ds_read_b128 v[16:19], v12 offset:0
    ds_read_b128 v[20:23], v12 offset:1024
    ds_read_b128 v[24:27], v12 offset:2048
    ds_read_b128 v[28:31], v12 offset:3072
    ds_read_b128 v[32:35], v12 offset:4096
    ds_read_b128 v[36:39], v12 offset:5120
    s_waitcnt lgkmcnt(4)
    v_pk_add_f32 v[112:113], v[112:113], v[16:17]
    v_pk_add_f32 v[114:115], v[114:115], v[18:19]
    v_pk_add_f32 v[116:117], v[116:117], v[20:21]
    v_pk_add_f32 v[118:119], v[118:119], v[22:23]
    s_waitcnt lgkmcnt(2)
    v_pk_add_f32 v[112:113], v[112:113], v[24:25]
    v_pk_add_f32 v[114:115], v[114:115], v[26:27]
    v_pk_add_f32 v[116:117], v[116:117], v[28:29]
    v_pk_add_f32 v[118:119], v[118:119], v[30:31]
    s_waitcnt lgkmcnt(0)
    v_pk_add_f32 v[112:113], v[112:113], v[32:33]
    v_pk_add_f32 v[114:115], v[114:115], v[34:35]
    v_pk_add_f32 v[116:117], v[116:117], v[36:37]
    v_pk_add_f32 v[118:119], v[118:119], v[38:39]
    v_cvt_pk_bf16_f32 v48, v112, v113
    v_cvt_pk_bf16_f32 v49, v114, v115
    v_cvt_pk_bf16_f32 v50, v116, v117
    v_cvt_pk_bf16_f32 v51, v118, v119
    s_nop 1
    v_permlane32_swap_b32 v48, v50
    v_permlane32_swap_b32 v49, v51
    buffer_store_dwordx4 v[48:51], v253, s[32:35], 0 offen
L_end:
    s_endpgm
L_oa_alt:
    s_waitcnt vmcnt(0)
L_oa_chk4_4:
    v_max3_u32 v3, v32, v33, v34
    v_max_u32 v3, v3, v35
    v_cmp_eq_u32 vcc, -1, v3
    s_cbranch_vccnz L_oa_retry4_4
L_oa_go4_4:
    s_waitcnt lgkmcnt(0)
    v_mfma_f32_32x32x16_bf16 v[128:143], v[84:87], v[32:35], v[128:143]
    v_mfma_f32_32x32x16_bf16 v[112:127], v[80:83], v[32:35], v[112:127]
L_oa_chk4_5:
    v_max3_u32 v3, v36, v37, v38
    v_max_u32 v3, v3, v39
    v_cmp_eq_u32 vcc, -1, v3
    s_cbranch_vccnz L_oa_retry4_5
L_oa_go4_5:
    s_waitcnt lgkmcnt(0)
    v_mfma_f32_32x32x16_bf16 v[128:143], v[92:95], v[36:39], v[128:143]
    v_mfma_f32_32x32x16_bf16 v[112:127], v[88:91], v[36:39], v[112:127]
L_oa_chk4_6:
    v_max3_u32 v3, v40, v41, v42
    v_max_u32 v3, v3, v43
    v_cmp_eq_u32 vcc, -1, v3
    s_cbranch_vccnz L_oa_retry4_6
L_oa_go4_6:
    s_waitcnt lgkmcnt(0)
    v_mfma_f32_32x32x16_bf16 v[128:143], v[100:103], v[40:43], v[128:143]
    v_mfma_f32_32x32x16_bf16 v[112:127], v[96:99], v[40:43], v[112:127]
L_oa_chk4_7:
    v_max3_u32 v3, v44, v45, v46
    v_max_u32 v3, v3, v47
    v_cmp_eq_u32 vcc, -1, v3
    s_cbranch_vccnz L_oa_retry4_7
L_oa_go4_7:
    s_waitcnt lgkmcnt(0)
    v_mfma_f32_32x32x16_bf16 v[128:143], v[108:111], v[44:47], v[128:143]
    v_mfma_f32_32x32x16_bf16 v[112:127], v[104:107], v[44:47], v[112:127]
L_oa_chk4_0:
    v_max3_u32 v3, v16, v17, v18
    v_max_u32 v3, v3, v19
    v_cmp_eq_u32 vcc, -1, v3
    s_cbranch_vccnz L_oa_retry4_0
L_oa_go4_0:
    s_waitcnt lgkmcnt(0)
    v_mfma_f32_32x32x16_bf16 v[128:143], v[52:55], v[16:19], v[128:143]
    ds_read_b32 v2, v1
    v_mfma_f32_32x32x16_bf16 v[112:127], v[48:51], v[16:19], v[112:127]
L_oa_chk4_1:
    v_max3_u32 v3, v20, v21, v22
    v_max_u32 v3, v3, v23
    v_cmp_eq_u32 vcc, -1, v3
    s_cbranch_vccnz L_oa_retry4_1
L_oa_go4_1:
    s_waitcnt lgkmcnt(0)
    v_mfma_f32_32x32x16_bf16 v[128:143], v[60:63], v[20:23], v[128:143]
L_oa_chk4_2:
    v_max3_u32 v3, v24, v25, v26
    v_max_u32 v3, v3, v27
    v_cmp_eq_u32 vcc, -1, v3
    s_cbranch_vccnz L_oa_retry4_2
L_oa_go4_2:
    s_waitcnt lgkmcnt(0)
    v_mfma_f32_32x32x16_bf16 v[128:143], v[68:71], v[24:27], v[128:143]
L_oa_chk4_3:
    v_max3_u32 v3, v28, v29, v30
    v_max_u32 v3, v3, v31
    v_cmp_eq_u32 vcc, -1, v3
    s_cbranch_vccnz L_oa_retry4_3
L_oa_go4_3:
    s_waitcnt lgkmcnt(0)
    v_mfma_f32_32x32x16_bf16 v[128:143], v[76:79], v[28:31], v[128:143]
    v_mfma_f32_32x32x16_bf16 v[112:127], v[56:59], v[20:23], v[112:127]
    s_mov_b32 s65, 100000
L_wb_41:
    s_waitcnt lgkmcnt(0)
    v_readfirstlane_b32 s49, v2
    s_sub_u32 s65, s65, 1
    s_cbranch_scc1 L_wbok_42
    s_cmp_eq_u32 s49, 8
    s_cbranch_scc1 L_wbok_42
    ds_read_b32 v2, v1
    s_branch L_wb_41
L_wbok_42:
    s_nop 3
    ds_write_b128 v14, v[128:131] offset:0
    ds_write_b128 v14, v[132:135] offset:1024
    v_mfma_f32_32x32x16_bf16 v[112:127], v[64:67], v[24:27], v[112:127]
    ds_write_b128 v15, v[136:139] offset:0
    ds_write_b128 v15, v[140:143] offset:1024
    v_mfma_f32_32x32x16_bf16 v[112:127], v[72:75], v[28:31], v[112:127]
    s_branch L_oa_join
L_oa_retry0_0:
    s_cmp_eq_u32 s65, 0
    s_cbranch_scc1 L_oa_go0_0
    s_sub_u32 s65, s65, 1
    buffer_load_dwordx4 v[16:19], v248, s[16:19], s53 offen offset:0 sc1
    buffer_load_dwordx4 v[20:23], v248, s[16:19], s53 offen offset:1024 sc1
    buffer_load_dwordx4 v[24:27], v248, s[16:19], s53 offen offset:2048 sc1
    buffer_load_dwordx4 v[28:31], v248, s[16:19], s53 offen offset:3072 sc1
    s_waitcnt vmcnt(0)
    s_branch L_oa_chk0_0
L_oa_retry0_1:
    s_cmp_eq_u32 s65, 0
    s_cbranch_scc1 L_oa_go0_1
    s_sub_u32 s65, s65, 1
    buffer_load_dwordx4 v[20:23], v248, s[16:19], s53 offen offset:1024 sc1
    buffer_load_dwordx4 v[24:27], v248, s[16:19], s53 offen offset:2048 sc1
    buffer_load_dwordx4 v[28:31], v248, s[16:19], s53 offen offset:3072 sc1
    s_waitcnt vmcnt(0)
    s_branch L_oa_chk0_1
L_oa_retry0_2:
    s_cmp_eq_u32 s65, 0
    s_cbranch_scc1 L_oa_go0_2
    s_sub_u32 s65, s65, 1
    buffer_load_dwordx4 v[24:27], v248, s[16:19], s53 offen offset:2048 sc1
    buffer_load_dwordx4 v[28:31], v248, s[16:19], s53 offen offset:3072 sc1
    s_waitcnt vmcnt(0)
    s_branch L_oa_chk0_2
L_oa_retry0_3:
    s_cmp_eq_u32 s65, 0
    s_cbranch_scc1 L_oa_go0_3
    s_sub_u32 s65, s65, 1
    buffer_load_dwordx4 v[28:31], v248, s[16:19], s53 offen offset:3072 sc1
    s_waitcnt vmcnt(0)
    s_branch L_oa_chk0_3
L_oa_retry0_4:
    s_cmp_eq_u32 s65, 0
    s_cbranch_scc1 L_oa_go0_4
    s_sub_u32 s65, s65, 1
    buffer_load_dwordx4 v[32:35], v248, s[16:19], s54 offen offset:0 sc1
    buffer_load_dwordx4 v[36:39], v248, s[16:19], s54 offen offset:1024 sc1
    buffer_load_dwordx4 v[40:43], v248, s[16:19], s54 offen offset:2048 sc1
    buffer_load_dwordx4 v[44:47], v248, s[16:19], s54 offen offset:3072 sc1
    s_waitcnt vmcnt(0)
    s_branch L_oa_chk0_4
L_oa_retry0_5:
    s_cmp_eq_u32 s65, 0
    s_cbranch_scc1 L_oa_go0_5
    s_sub_u32 s65, s65, 1
    buffer_load_dwordx4 v[36:39], v248, s[16:19], s54 offen offset:1024 sc1
    buffer_load_dwordx4 v[40:43], v248, s[16:19], s54 offen offset:2048 sc1
    buffer_load_dwordx4 v[44:47], v248, s[16:19], s54 offen offset:3072 sc1
    s_waitcnt vmcnt(0)
    s_branch L_oa_chk0_5
L_oa_retry0_6:
    s_cmp_eq_u32 s65, 0
    s_cbranch_scc1 L_oa_go0_6
    s_sub_u32 s65, s65, 1
    buffer_load_dwordx4 v[40:43], v248, s[16:19], s54 offen offset:2048 sc1
    buffer_load_dwordx4 v[44:47], v248, s[16:19], s54 offen offset:3072 sc1
    s_waitcnt vmcnt(0)
    s_branch L_oa_chk0_6
L_oa_retry0_7:
    s_cmp_eq_u32 s65, 0
    s_cbranch_scc1 L_oa_go0_7
    s_sub_u32 s65, s65, 1
    buffer_load_dwordx4 v[44:47], v248, s[16:19], s54 offen offset:3072 sc1
    s_waitcnt vmcnt(0)
    s_branch L_oa_chk0_7
L_oa_retry4_0:
    s_cmp_eq_u32 s65, 0
    s_cbranch_scc1 L_oa_go4_0
    s_sub_u32 s65, s65, 1
    buffer_load_dwordx4 v[16:19], v248, s[16:19], s53 offen offset:0 sc1
    buffer_load_dwordx4 v[20:23], v248, s[16:19], s53 offen offset:1024 sc1
    buffer_load_dwordx4 v[24:27], v248, s[16:19], s53 offen offset:2048 sc1
    buffer_load_dwordx4 v[28:31], v248, s[16:19], s53 offen offset:3072 sc1
    s_waitcnt vmcnt(0)
    s_branch L_oa_chk4_0
L_oa_retry4_1:
    s_cmp_eq_u32 s65, 0
    s_cbranch_scc1 L_oa_go4_1
    s_sub_u32 s65, s65, 1
    buffer_load_dwordx4 v[20:23], v248, s[16:19], s53 offen offset:1024 sc1
    buffer_load_dwordx4 v[24:27], v248, s[16:19], s53 offen offset:2048 sc1
    buffer_load_dwordx4 v[28:31], v248, s[16:19], s53 offen offset:3072 sc1
    s_waitcnt vmcnt(0)
    s_branch L_oa_chk4_1
L_oa_retry4_2:
    s_cmp_eq_u32 s65, 0
    s_cbranch_scc1 L_oa_go4_2
    s_sub_u32 s65, s65, 1
    buffer_load_dwordx4 v[24:27], v248, s[16:19], s53 offen offset:2048 sc1
    buffer_load_dwordx4 v[28:31], v248, s[16:19], s53 offen offset:3072 sc1
    s_waitcnt vmcnt(0)
    s_branch L_oa_chk4_2
L_oa_retry4_3:
    s_cmp_eq_u32 s65, 0
    s_cbranch_scc1 L_oa_go4_3
    s_sub_u32 s65, s65, 1
    buffer_load_dwordx4 v[28:31], v248, s[16:19], s53 offen offset:3072 sc1
    s_waitcnt vmcnt(0)
    s_branch L_oa_chk4_3
L_oa_retry4_4:
    s_cmp_eq_u32 s65, 0
    s_cbranch_scc1 L_oa_go4_4
    s_sub_u32 s65, s65, 1
    buffer_load_dwordx4 v[32:35], v248, s[16:19], s54 offen offset:0 sc1
    buffer_load_dwordx4 v[36:39], v248, s[16:19], s54 offen offset:1024 sc1
    buffer_load_dwordx4 v[40:43], v248, s[16:19], s54 offen offset:2048 sc1
    buffer_load_dwordx4 v[44:47], v248, s[16:19], s54 offen offset:3072 sc1
    s_waitcnt vmcnt(0)
    s_branch L_oa_chk4_4
L_oa_retry4_5:
    s_cmp_eq_u32 s65, 0
    s_cbranch_scc1 L_oa_go4_5
    s_sub_u32 s65, s65, 1
    buffer_load_dwordx4 v[36:39], v248, s[16:19], s54 offen offset:1024 sc1
    buffer_load_dwordx4 v[40:43], v248, s[16:19], s54 offen offset:2048 sc1
    buffer_load_dwordx4 v[44:47], v248, s[16:19], s54 offen offset:3072 sc1
    s_waitcnt vmcnt(0)
    s_branch L_oa_chk4_5
L_oa_retry4_6:
    s_cmp_eq_u32 s65, 0
    s_cbranch_scc1 L_oa_go4_6
    s_sub_u32 s65, s65, 1
    buffer_load_dwordx4 v[40:43], v248, s[16:19], s54 offen offset:2048 sc1
    buffer_load_dwordx4 v[44:47], v248, s[16:19], s54 offen offset:3072 sc1
    s_waitcnt vmcnt(0)
    s_branch L_oa_chk4_6
L_oa_retry4_7:
    s_cmp_eq_u32 s65, 0
    s_cbranch_scc1 L_oa_go4_7
    s_sub_u32 s65, s65, 1
    buffer_load_dwordx4 v[44:47], v248, s[16:19], s54 offen offset:3072 sc1
    s_waitcnt vmcnt(0)
    s_branch L_oa_chk4_7
L_fallback:
    s_mov_b32 s64, 1
    s_waitcnt vmcnt(0) lgkmcnt(0)
    v_mov_b32 v244, 0xff800000
    v_mov_b32 v245, 0xff800000
    s_mov_b32 s53, 0
L_fb_loop:
    s_add_u32 s49, s53, s58
    buffer_load_dwordx4 v[112:115], v248, s[16:19], s49 offen sc1
    s_waitcnt vmcnt(0)
    v_mfma_f32_32x32x16_bf16 v[16:31], v[112:115], v[4:7], 0
    v_mfma_f32_32x32x16_bf16 v[32:47], v[112:115], v[8:11], 0
    s_nop 11
    v_max3_f32 v244, v16, v17, v244
    v_max3_f32 v244, v18, v19, v244
    v_max3_f32 v244, v20, v21, v244
    v_max3_f32 v244, v22, v23, v244
    v_max3_f32 v244, v24, v25, v244
    v_max3_f32 v244, v26, v27, v244
    v_max3_f32 v244, v28, v29, v244
    v_max3_f32 v244, v30, v31, v244
    v_max3_f32 v245, v32, v33, v245
    v_max3_f32 v245, v34, v35, v245
    v_max3_f32 v245, v36, v37, v245
    v_max3_f32 v245, v38, v39, v245
    v_max3_f32 v245, v40, v41, v245
    v_max3_f32 v245, v42, v43, v245
    v_max3_f32 v245, v44, v45, v245
    v_max3_f32 v245, v46, v47, v245
    s_add_u32 s53, s53, 2048
    s_cmp_lt_u32 s53, 65536
    s_cbranch_scc1 L_fb_loop
    v_mov_b32 v246, v244
    v_mov_b32 v247, v245
    s_nop 1
    v_permlane32_swap_b32 v244, v246
    v_permlane32_swap_b32 v245, v247
    v_max_f32 v244, v244, v246
    v_max_f32 v245, v245, v247
    s_lshl_b32 s49, s47, 9
    s_add_u32 s49, s49, 151552
    v_lshl_add_u32 v1, v255, 2, s49
    v_xor_b32 v2, 2048, v1
    ds_write_b32 v1, v244
    ds_write_b32 v1, v245 offset:256
    s_waitcnt lgkmcnt(0)
    s_barrier
    ds_read_b32 v246, v2 offset:256
    ds_read_b32 v247, v2
    s_waitcnt lgkmcnt(0)
    v_max_f32 v244, v244, v246
    v_max_f32 v245, v245, v247
    v_sub_f32 v80, 0, v244
    v_sub_f32 v96, 0, v245
    v_sub_f32 v81, 0, v244
    v_sub_f32 v97, 0, v245
    v_sub_f32 v82, 0, v244
    v_sub_f32 v98, 0, v245
    v_sub_f32 v83, 0, v244
    v_sub_f32 v99, 0, v245
    v_sub_f32 v84, 0, v244
    v_sub_f32 v100, 0, v245
    v_sub_f32 v85, 0, v244
    v_sub_f32 v101, 0, v245
    v_sub_f32 v86, 0, v244
    v_sub_f32 v102, 0, v245
    v_sub_f32 v87, 0, v244
    v_sub_f32 v103, 0, v245
    v_sub_f32 v88, 0, v244
    v_sub_f32 v104, 0, v245
    v_sub_f32 v89, 0, v244
    v_sub_f32 v105, 0, v245
    v_sub_f32 v90, 0, v244
    v_sub_f32 v106, 0, v245
    v_sub_f32 v91, 0, v244
    v_sub_f32 v107, 0, v245
    v_sub_f32 v92, 0, v244
    v_sub_f32 v108, 0, v245
    v_sub_f32 v93, 0, v244
    v_sub_f32 v109, 0, v245
    v_sub_f32 v94, 0, v244
    v_sub_f32 v110, 0, v245
    v_sub_f32 v95, 0, v244
    v_sub_f32 v111, 0, v245
    v_and_b32 v1, 27, v255
    v_cmp_eq_u32 vcc, 16, v1
    v_mov_b32 v2, 0
    v_mov_b32 v3, 0x3f803f80
    v_cndmask_b32 v1, v2, v3, vcc
    v_mov_b32 v192, v1
    v_mov_b32 v216, v1
    v_mov_b32 v193, v1
    v_mov_b32 v217, v1
    v_mov_b32 v194, v1
    v_mov_b32 v218, v1
    v_mov_b32 v195, v1
    v_mov_b32 v219, v1
    v_mov_b32 v196, v1
    v_mov_b32 v220, v1
    v_mov_b32 v197, v1
    v_mov_b32 v221, v1
    v_mov_b32 v198, v1
    v_mov_b32 v222, v1
    v_mov_b32 v199, v1
    v_mov_b32 v223, v1
    v_mov_b32 v200, v1
    v_mov_b32 v224, v1
    v_mov_b32 v201, v1
    v_mov_b32 v225, v1
    v_mov_b32 v202, v1
    v_mov_b32 v226, v1
    v_mov_b32 v203, v1
    v_mov_b32 v227, v1
    v_mov_b32 v204, v1
    v_mov_b32 v228, v1
    v_mov_b32 v205, v1
    v_mov_b32 v229, v1
    v_mov_b32 v206, v1
    v_mov_b32 v230, v1
    v_mov_b32 v207, v1
    v_mov_b32 v231, v1
    s_mov_b32 s59, s61
    s_add_u32 s60, s59, s58
    s_mov_b64 exec, s[62:63]
    buffer_load_dwordx4 v[192:195], v249, s[16:19], s60 offen sc1
    s_mov_b64 exec, -1
    buffer_load_dwordx4 v[112:115], v248, s[16:19], s60 offen sc1
    s_mov_b64 exec, s[62:63]
    buffer_load_dwordx4 v[216:219], v249, s[16:19], s60 offen offset:512 sc1
    s_add_u32 s59, s59, 2048
    s_and_b32 s59, s59, 0xffff
    s_add_u32 s60, s59, s58
    buffer_load_dwordx4 v[196:199], v249, s[16:19], s60 offen sc1
    s_mov_b64 exec, -1
    buffer_load_dwordx4 v[116:119], v248, s[16:19], s60 offen sc1
    s_mov_b64 exec, s[62:63]
    buffer_load_dwordx4 v[220:223], v249, s[16:19], s60 offen offset:512 sc1
    s_add_u32 s59, s59, 2048
    s_and_b32 s59, s59, 0xffff
    s_add_u32 s60, s59, s58
    buffer_load_dwordx4 v[200:203], v249, s[16:19], s60 offen sc1
    s_mov_b64 exec, -1
    buffer_load_dwordx4 v[120:123], v248, s[16:19], s60 offen sc1
    s_mov_b64 exec, s[62:63]
    buffer_load_dwordx4 v[224:227], v249, s[16:19], s60 offen offset:512 sc1
    s_add_u32 s59, s59, 2048
    s_and_b32 s59, s59, 0xffff
    s_add_u32 s60, s59, s58
    buffer_load_dwordx4 v[204:207], v249, s[16:19], s60 offen sc1
    s_mov_b64 exec, -1
    buffer_load_dwordx4 v[124:127], v248, s[16:19], s60 offen sc1
    v_mov_b64 v[48:49], 0
    v_mov_b64 v[50:51], 0
    v_mov_b64 v[52:53], 0
    v_mov_b64 v[54:55], 0
    v_mov_b64 v[56:57], 0
    v_mov_b64 v[64:65], 0
    v_mov_b64 v[66:67], 0
    v_mov_b64 v[68:69], 0
    v_mov_b64 v[70:71], 0
    v_mov_b64 v[72:73], 0
    v_mov_b64 v[40:41], 0
    v_mov_b64 v[42:43], 0
    v_mov_b64 v[44:45], 0
    v_mov_b64 v[46:47], 0
    s_waitcnt vmcnt(6)
    v_mfma_f32_32x32x16_bf16 v[16:31], v[112:115], v[4:7], v[80:95]
    s_nop 11
    s_mov_b32 s53, 8
L_fb_run:
    s_setprio 1
    v_exp_f32 v16, v16
    s_setprio 2
    v_exp_f32 v17, v17
    v_smfmac_f32_32x32x32_bf16 v[64:79], v[228:231], v[40:47], v250
    v_exp_f32 v18, v18
    v_exp_f32 v19, v19
    v_exp_f32 v20, v20
    v_mfma_f32_32x32x16_bf16 v[32:47], v[112:115], v[8:11], v[96:111]
    v_exp_f32 v21, v21
    v_exp_f32 v22, v22
    v_exp_f32 v23, v23
    v_exp_f32 v24, v24
    v_exp_f32 v25, v25
    v_smfmac_f32_32x32x32_bf16 v[48:63], v[192:195], v[16:23], v250
    v_exp_f32 v26, v26
    v_exp_f32 v27, v27
    v_exp_f32 v28, v28
    v_exp_f32 v29, v29
    v_exp_f32 v30, v30
    v_exp_f32 v31, v31
    v_exp_f32 v32, v32
    v_exp_f32 v33, v33
    v_smfmac_f32_32x32x32_bf16 v[48:63], v[216:219], v[24:31], v250
    v_exp_f32 v34, v34
    v_exp_f32 v35, v35
    v_exp_f32 v36, v36
    v_mfma_f32_32x32x16_bf16 v[16:31], v[116:119], v[4:7], v[80:95]
    v_exp_f32 v37, v37
    v_exp_f32 v38, v38
    v_exp_f32 v39, v39
    v_exp_f32 v40, v40
    v_exp_f32 v41, v41
    v_smfmac_f32_32x32x32_bf16 v[64:79], v[192:195], v[32:39], v250
    v_exp_f32 v42, v42
    v_exp_f32 v43, v43
    v_exp_f32 v44, v44
    v_exp_f32 v45, v45
    v_exp_f32 v46, v46
    v_exp_f32 v47, v47
    s_setprio 0
    s_mov_b64 exec, s[62:63]
    buffer_load_dwordx4 v[228:231], v249, s[16:19], s60 offen offset:512 sc1
    s_add_u32 s59, s59, 2048
    s_and_b32 s59, s59, 0xffff
    s_add_u32 s60, s59, s58
    buffer_load_dwordx4 v[192:195], v249, s[16:19], s60 offen sc1
    s_mov_b64 exec, -1
    buffer_load_dwordx4 v[112:115], v248, s[16:19], s60 offen sc1
    s_waitcnt vmcnt(6)
    s_setprio 1
    v_exp_f32 v16, v16
    s_setprio 2
    v_exp_f32 v17, v17
    v_smfmac_f32_32x32x32_bf16 v[64:79], v[216:219], v[40:47], v250
    v_exp_f32 v18, v18
    v_exp_f32 v19, v19
    v_exp_f32 v20, v20
    v_mfma_f32_32x32x16_bf16 v[32:47], v[116:119], v[8:11], v[96:111]
    v_exp_f32 v21, v21
    v_exp_f32 v22, v22
    v_exp_f32 v23, v23
    v_exp_f32 v24, v24
    v_exp_f32 v25, v25
    v_smfmac_f32_32x32x32_bf16 v[48:63], v[196:199], v[16:23], v250
    v_exp_f32 v26, v26
    v_exp_f32 v27, v27
    v_exp_f32 v28, v28
    v_exp_f32 v29, v29
    v_exp_f32 v30, v30
    v_exp_f32 v31, v31
    v_exp_f32 v32, v32
    v_exp_f32 v33, v33
    v_smfmac_f32_32x32x32_bf16 v[48:63], v[220:223], v[24:31], v250
    v_exp_f32 v34, v34
    v_exp_f32 v35, v35
    v_exp_f32 v36, v36
    v_mfma_f32_32x32x16_bf16 v[16:31], v[120:123], v[4:7], v[80:95]
    v_exp_f32 v37, v37
    v_exp_f32 v38, v38
    v_exp_f32 v39, v39
    v_exp_f32 v40, v40
    v_exp_f32 v41, v41
    v_smfmac_f32_32x32x32_bf16 v[64:79], v[196:199], v[32:39], v250
    v_exp_f32 v42, v42
    v_exp_f32 v43, v43
    v_exp_f32 v44, v44
    v_exp_f32 v45, v45
    v_exp_f32 v46, v46
    v_exp_f32 v47, v47
    s_setprio 0
    s_mov_b64 exec, s[62:63]
    buffer_load_dwordx4 v[216:219], v249, s[16:19], s60 offen offset:512 sc1
    s_add_u32 s59, s59, 2048
    s_and_b32 s59, s59, 0xffff
    s_add_u32 s60, s59, s58
    buffer_load_dwordx4 v[196:199], v249, s[16:19], s60 offen sc1
    s_mov_b64 exec, -1
    buffer_load_dwordx4 v[116:119], v248, s[16:19], s60 offen sc1
    s_waitcnt vmcnt(6)
    s_setprio 1
    v_exp_f32 v16, v16
    s_setprio 2
    v_exp_f32 v17, v17
    v_smfmac_f32_32x32x32_bf16 v[64:79], v[220:223], v[40:47], v250
    v_exp_f32 v18, v18
    v_exp_f32 v19, v19
    v_exp_f32 v20, v20
    v_mfma_f32_32x32x16_bf16 v[32:47], v[120:123], v[8:11], v[96:111]
    v_exp_f32 v21, v21
    v_exp_f32 v22, v22
    v_exp_f32 v23, v23
    v_exp_f32 v24, v24
    v_exp_f32 v25, v25
    v_smfmac_f32_32x32x32_bf16 v[48:63], v[200:203], v[16:23], v250
    v_exp_f32 v26, v26
    v_exp_f32 v27, v27
    v_exp_f32 v28, v28
    v_exp_f32 v29, v29
    v_exp_f32 v30, v30
    v_exp_f32 v31, v31
    v_exp_f32 v32, v32
    v_exp_f32 v33, v33
    v_smfmac_f32_32x32x32_bf16 v[48:63], v[224:227], v[24:31], v250
    v_exp_f32 v34, v34
    v_exp_f32 v35, v35
    v_exp_f32 v36, v36
    v_mfma_f32_32x32x16_bf16 v[16:31], v[124:127], v[4:7], v[80:95]
    v_exp_f32 v37, v37
    v_exp_f32 v38, v38
    v_exp_f32 v39, v39
    v_exp_f32 v40, v40
    v_exp_f32 v41, v41
    v_smfmac_f32_32x32x32_bf16 v[64:79], v[200:203], v[32:39], v250
    v_exp_f32 v42, v42
    v_exp_f32 v43, v43
    v_exp_f32 v44, v44
    v_exp_f32 v45, v45
    v_exp_f32 v46, v46
    v_exp_f32 v47, v47
    s_setprio 0
    s_mov_b64 exec, s[62:63]
    buffer_load_dwordx4 v[220:223], v249, s[16:19], s60 offen offset:512 sc1
    s_add_u32 s59, s59, 2048
    s_and_b32 s59, s59, 0xffff
    s_add_u32 s60, s59, s58
    buffer_load_dwordx4 v[200:203], v249, s[16:19], s60 offen sc1
    s_mov_b64 exec, -1
    buffer_load_dwordx4 v[120:123], v248, s[16:19], s60 offen sc1
    s_waitcnt vmcnt(6)
    s_setprio 1
    v_exp_f32 v16, v16
    s_setprio 2
    v_exp_f32 v17, v17
    v_smfmac_f32_32x32x32_bf16 v[64:79], v[224:227], v[40:47], v250
    v_exp_f32 v18, v18
    v_exp_f32 v19, v19
    v_exp_f32 v20, v20
    v_mfma_f32_32x32x16_bf16 v[32:47], v[124:127], v[8:11], v[96:111]
    v_exp_f32 v21, v21
    v_exp_f32 v22, v22
    v_exp_f32 v23, v23
    v_exp_f32 v24, v24
    v_exp_f32 v25, v25
    v_smfmac_f32_32x32x32_bf16 v[48:63], v[204:207], v[16:23], v250
    v_exp_f32 v26, v26
    v_exp_f32 v27, v27
    v_exp_f32 v28, v28
    v_exp_f32 v29, v29
    v_exp_f32 v30, v30
    v_exp_f32 v31, v31
    v_exp_f32 v32, v32
    v_exp_f32 v33, v33
    v_smfmac_f32_32x32x32_bf16 v[48:63], v[228:231], v[24:31], v250
    v_exp_f32 v34, v34
    v_exp_f32 v35, v35
    v_exp_f32 v36, v36
    v_mfma_f32_32x32x16_bf16 v[16:31], v[112:115], v[4:7], v[80:95]
    v_exp_f32 v37, v37
    v_exp_f32 v38, v38
    v_exp_f32 v39, v39
    v_exp_f32 v40, v40
    v_exp_f32 v41, v41
    v_smfmac_f32_32x32x32_bf16 v[64:79], v[204:207], v[32:39], v250
    v_exp_f32 v42, v42
    v_exp_f32 v43, v43
    v_exp_f32 v44, v44
    v_exp_f32 v45, v45
    v_exp_f32 v46, v46
    v_exp_f32 v47, v47
    s_setprio 0
    s_mov_b64 exec, s[62:63]
    buffer_load_dwordx4 v[224:227], v249, s[16:19], s60 offen offset:512 sc1
    s_add_u32 s59, s59, 2048
    s_and_b32 s59, s59, 0xffff
    s_add_u32 s60, s59, s58
    buffer_load_dwordx4 v[204:207], v249, s[16:19], s60 offen sc1
    s_mov_b64 exec, -1
    buffer_load_dwordx4 v[124:127], v248, s[16:19], s60 offen sc1
    s_waitcnt vmcnt(6)
    s_sub_u32 s53, s53, 1
    s_cmp_lg_u32 s53, 0
    s_cbranch_scc1 L_fb_run
    s_xor_b32 s49, s47, 4
    s_lshl_b32 s50, s49, 11
    s_add_u32 s50, s50, 65536
    v_add_u32 v1, s50, v248
    s_lshl_b32 s50, s49, 8
    s_add_u32 s50, s50, 149504
    v_smfmac_f32_32x32x32_bf16 v[64:79], v[228:231], v[40:47], v250
    v_lshl_add_u32 v2, v255, 2, s50
    ds_write_b128 v1, v[48:51]
    ds_write_b128 v1, v[52:55] offset:1024
    ds_write_b32 v2, v56
    s_waitcnt vmcnt(0)
    s_branch L_attn_done
L_codeend:
.section .rodata,"a"
.p2align 6
.amdhsa_kernel gated_mix__softmax_full_mha__linear_attn_block__prompt_kernel
  .amdhsa_next_free_vgpr 256
  .amdhsa_next_free_sgpr 102
  .amdhsa_accum_offset 256
  .amdhsa_group_segment_fixed_size 0
  .amdhsa_kernarg_size 80
  .amdhsa_user_sgpr_count 2
  .amdhsa_user_sgpr_kernarg_segment_ptr 1
  .amdhsa_system_sgpr_workgroup_id_x 1
.end_amdhsa_kernel
```
